```python
import torch

def _softmax(x, axis=-1):
    return torch.softmax(x, dim=axis)
def _gelu(x):
    return torch.nn.functional.gelu(x, approximate="tanh")
def _silu(x):
    return torch.nn.functional.silu(x)
def _sigmoid(x):
    return torch.sigmoid(x)
def _layernorm(x, axis=-1, eps=1e-5):
    m = x.mean(dim=axis, keepdim=True)
    v = x.var(dim=axis, keepdim=True, unbiased=False)
    return (x - m) / torch.sqrt(v + eps)
def _scatter_add(tgt, idx, src, axis=0):
    return tgt.clone().index_add_(axis, idx, src)
def _segment_sum(src, seg, n):
    out = torch.zeros((n,) + src.shape[1:], dtype=src.dtype)
    return out.index_add_(0, seg, src)
def _pad(x, pw):
    flat = tuple(v for pair in reversed(pw) for v in pair)
    return torch.nn.functional.pad(x, flat)

kernel_name = 'concat_heads__sliding_block_cached__gqa_block_cached__decode'

def setup_inputs():

    _w = (lambda a: (lambda t: t.to(torch.bfloat16) if t.is_floating_point() else t)(torch.as_tensor(a)))
    def _A_setup():
        B, Sq, D = 1, 1, 640
        Hq, Hkv, Sk, Dh = 32, 32, 4096, 128
        assert Hq % Hkv == 0, (Hq, Hkv)
        return {
            "x": _w((lambda *s: torch.randn(*s, dtype=torch.bfloat16) * 0.2)(B, Sq, D)),
            "k_cache": _w((lambda *s: torch.randn(*s, dtype=torch.bfloat16) * 3.2)(B, Hkv, Sk, Dh)),
            "v_cache": _w((lambda *s: torch.randn(*s, dtype=torch.bfloat16) * 1.6)(B, Hkv, Sk, Dh)),
            "wq": _w((lambda *s: torch.randn(*s, dtype=torch.bfloat16) * 3.2)(D, Hq * Dh) * (D ** -0.5)),
            "wo": _w((lambda *s: torch.randn(*s, dtype=torch.bfloat16) * 1.6)(Hq * Dh, D) * ((Hq * Dh) ** -0.5)),
        }
    _A_in = _A_setup()

    def _B_setup():
        B, Sq, D = 1, 1, 640
        Hq, Hkv, Sk, Dh = 32, 32, 4096, 128
        assert Hq % Hkv == 0, (Hq, Hkv)
        return {
            "x": _w((lambda *s: torch.randn(*s, dtype=torch.bfloat16) * 0.4)(B, Sq, D)),
            "k_cache": _w((lambda *s: torch.randn(*s, dtype=torch.bfloat16) * 3.2)(B, Hkv, Sk, Dh)),
            "v_cache": _w((lambda *s: torch.randn(*s, dtype=torch.bfloat16) * 0.8)(B, Hkv, Sk, Dh)),
            "wq": _w((lambda *s: torch.randn(*s, dtype=torch.bfloat16) * 3.2)(D, Hq * Dh) * (D ** -0.5)),
            "wo": _w((lambda *s: torch.randn(*s, dtype=torch.bfloat16) * 0.8)(Hq * Dh, D) * ((Hq * Dh) ** -0.5)),
        }
    _B_in = _B_setup()

    return {
        "A_x": _A_in["x"],
        "A_k_cache": _A_in["k_cache"],
        "A_v_cache": _A_in["v_cache"],
        "A_wq": _A_in["wq"],
        "A_wo": _A_in["wo"],
        "B_x": _B_in["x"],
        "B_k_cache": _B_in["k_cache"],
        "B_v_cache": _B_in["v_cache"],
        "B_wq": _B_in["wq"],
        "B_wo": _B_in["wo"],
    }

def reference(A_x, A_k_cache, A_v_cache, A_wq, A_wo, B_x, B_k_cache, B_v_cache, B_wq, B_wo):
    def _A_ref(x, k_cache, v_cache, wq, wo):
        B, Sq, D = x.shape
        Hq, Dh = 32, 128
        Hkv, Sk = k_cache.shape[1], k_cache.shape[2]
        W = min(4096, max(256, Sk // 4))
        rep = Hq // Hkv
        q = (lambda x, *d: x.permute(*d))((x @ wq).reshape(B, Sq, Hq, Dh), 0, 2, 1, 3)
        k = (lambda x, n, axis: torch.repeat_interleave(x, n, dim=axis))(k_cache[:, :, Sk - W:, :], rep, axis=1)
        v = (lambda x, n, axis: torch.repeat_interleave(x, n, dim=axis))(v_cache[:, :, Sk - W:, :], rep, axis=1)
        scores = torch.einsum("bhqd,bhkd->bhqk", q, k) * (Dh ** -0.5)
        p = _softmax(scores, axis=-1)
        o = torch.einsum("bhqk,bhkd->bhqd", p, v)
        return (lambda x, *d: x.permute(*d))(o, 0, 2, 1, 3).reshape(B, Sq, Hq * Dh) @ wo

    def _B_ref(x, k_cache, v_cache, wq, wo):
        B, Sq, D = x.shape
        Hq, Dh = 32, 128
        Hkv = k_cache.shape[1]
        rep = Hq // Hkv
        q = (lambda x, *d: x.permute(*d))((x @ wq).reshape(B, Sq, Hq, Dh), 0, 2, 1, 3)
        k = (lambda x, n, axis: torch.repeat_interleave(x, n, dim=axis))(k_cache, rep, axis=1)
        v = (lambda x, n, axis: torch.repeat_interleave(x, n, dim=axis))(v_cache, rep, axis=1)
        scores = torch.einsum("bhqd,bhkd->bhqk", q, k) * (Dh ** -0.5)
        p = _softmax(scores, axis=-1)
        o = torch.einsum("bhqk,bhkd->bhqd", p, v)
        return (lambda x, *d: x.permute(*d))(o, 0, 2, 1, 3).reshape(B, Sq, Hq * Dh) @ wo

    a = _A_ref(A_x, A_k_cache, A_v_cache, A_wq, A_wo)
    b = _B_ref(B_x, B_k_cache, B_v_cache, B_wq, B_wo)
    return torch.concatenate([a, b], axis=-1)
```

```asm
; @launch grid=(256,1,1) block=(576,1,1) lds=55040
.amdgcn_target "amdgcn-amd-amdhsa--gfx950"
.text
.globl concat_heads__sliding_block_cached__gqa_block_cached__decode_kernel
.p2align 8
.type concat_heads__sliding_block_cached__gqa_block_cached__decode_kernel,@function
concat_heads__sliding_block_cached__gqa_block_cached__decode_kernel:
  s_cmp_ge_u32 s2, 256
  s_cbranch_scc1 L_end
  s_load_dwordx16 s[4:19], s[0:1], 0
  s_load_dwordx8 s[20:27], s[0:1], 64
  s_load_dwordx2 s[28:29], s[0:1], 96
  s_getpc_b64 s[68:69]
  s_lshr_b32 s60, s2, 3
  s_and_b32 s60, s60, 31
  s_lshl_b32 s60, s60, 9
  v_lshlrev_b32 v1, 4, v0
  v_add_u32 v1, s60, v1
  v_cmp_gt_u32 vcc, 32, v0
  s_nop 0
  s_and_saveexec_b64 s[66:67], vcc
  s_cbranch_execz L_pfskip
  global_load_dwordx4 v[164:167], v1, s[68:69]
L_pfskip:
  s_mov_b64 exec, s[66:67]
  v_lshrrev_b32 v1, 6, v0
  v_and_b32 v0, 63, v0
  v_readfirstlane_b32 s3, v1
  s_lshr_b32 s30, s2, 3
  s_and_b32 s31, s2, 7
  s_mul_i32 s96, s30, 0
  s_add_u32 s96, s96, s31
  s_and_b32 s96, s96, 7
  s_lshl_b32 s56, s30, 3
  s_add_u32 s56, s56, s31
  s_and_b32 s100, s31, 1
  s_mul_i32 s101, s100, 3
  s_lshl_b32 s100, s100, 1
  s_sub_u32 s100, 6, s100
  s_bfe_u32 s60, s31, 0x10001
  s_mul_i32 s60, s60, 5
  s_add_u32 s101, s101, s60
  s_mov_b32 s57, 0xffff0000
  s_mov_b32 s58, 0x3e0293ee
  s_mov_b32 s59, 0xfffffffe
  s_mov_b32 s61, 1048576
  s_mov_b64 s[90:91], -1
  s_mov_b32 s93, s3
  s_mov_b32 s94, s2
  s_mov_b32 s95, 0
  v_mov_b32 v7, 0
  v_lshlrev_b32 v2, 4, v0
  s_cmp_eq_u32 s3, 8
  s_cbranch_scc1 L_helper
  v_lshrrev_b32 v1, 4, v0
  v_and_b32 v6, 15, v0
  v_lshlrev_b32 v6, 4, v6
  v_lshlrev_b32 v3, 13, v1
  v_add_u32 v3, v3, v6
  v_lshlrev_b32 v4, 1, v1
  v_lshlrev_b32 v5, 3, v1
  v_lshl_add_u32 v5, v6, 1, v5
  s_and_b32 s62, s3, 3
  s_mul_i32 s62, s62, 20
  s_mul_i32 s63, s31, 80
  s_add_u32 s62, s62, s63
  s_lshl_b32 s63, s62, 1
  s_lshl_b32 s62, s62, 13
  s_lshl_b32 s64, s30, 8
  s_add_u32 s62, s62, s64
  s_mov_b32 s50, 0x500000
  s_mov_b32 s51, 0x00020000
  s_mov_b32 s54, 1280
  s_mov_b32 s55, 0x00020000
  s_lshl_b32 s64, s30, 20
  s_lshl_b32 s65, s3, 10
  s_add_u32 s64, s64, s65
  s_lshl_b32 s65, s96, 15
  s_add_u32 s65, s65, s64
  s_add_u32 s65, s65, 0xC0000
  s_mul_i32 s66, s96, 131072
  s_add_u32 s66, s66, s64
  s_add_u32 s64, s64, 65536
  s_mov_b32 s34, 0x2000000
  s_mov_b32 s35, 0x00020000
  s_mov_b32 s38, 0x2000000
  s_mov_b32 s39, 0x00020000
  s_mov_b32 s42, 0x2000000
  s_mov_b32 s43, 0x00020000
  s_mov_b32 s46, 0x2000000
  s_mov_b32 s47, 0x00020000
  s_cmp_lt_u32 s3, 4
  s_waitcnt lgkmcnt(0)
  s_cselect_b32 s48, s10, s20
  s_cselect_b32 s49, s11, s21
  s_cselect_b32 s52, s4, s14
  s_cselect_b32 s53, s5, s15
  s_mov_b32 s32, s6
  s_mov_b32 s33, s7
  s_mov_b32 s36, s8
  s_mov_b32 s37, s9
  s_mov_b32 s40, s16
  s_mov_b32 s41, s17
  s_mov_b32 s44, s18
  s_mov_b32 s45, s19
  buffer_load_ushort v40, v4, s[52:55], s63 offen offset:0
  buffer_load_ushort v41, v4, s[52:55], s63 offen offset:8
  buffer_load_ushort v42, v4, s[52:55], s63 offen offset:16
  buffer_load_ushort v43, v4, s[52:55], s63 offen offset:24
  buffer_load_ushort v44, v4, s[52:55], s63 offen offset:32
  buffer_load_dwordx4 v[144:147], v3, s[48:51], s62 offen nt
  s_add_u32 s62, s62, 0x8000
  buffer_load_dwordx4 v[148:151], v3, s[48:51], s62 offen nt
  s_add_u32 s62, s62, 0x8000
  buffer_load_dwordx4 v[152:155], v3, s[48:51], s62 offen nt
  s_add_u32 s62, s62, 0x8000
  buffer_load_dwordx4 v[156:159], v3, s[48:51], s62 offen nt
  s_add_u32 s62, s62, 0x8000
  buffer_load_dwordx4 v[160:163], v3, s[48:51], s62 offen nt
  s_barrier
  s_waitcnt vmcnt(3)
  s_add_u32 s67, s65, 0
  buffer_load_dwordx4 v[64:67], v2, s[32:35], s67 offen nt
  s_waitcnt vmcnt(3)
  s_add_u32 s67, s65, 8192
  buffer_load_dwordx4 v[68:71], v2, s[32:35], s67 offen nt
  s_waitcnt vmcnt(3)
  s_add_u32 s67, s65, 16384
  buffer_load_dwordx4 v[72:75], v2, s[32:35], s67 offen nt
  s_waitcnt vmcnt(3)
  s_add_u32 s67, s65, 24576
  buffer_load_dwordx4 v[76:79], v2, s[32:35], s67 offen nt
  v_lshlrev_b32 v40, 16, v40
  v_lshlrev_b32 v41, 16, v41
  v_lshlrev_b32 v42, 16, v42
  v_lshlrev_b32 v43, 16, v43
  v_lshlrev_b32 v44, 16, v44
  v_lshlrev_b32 v32, 16, v144
  v_and_b32 v33, s57, v144
  v_lshlrev_b32 v34, 16, v145
  v_and_b32 v35, s57, v145
  v_lshlrev_b32 v36, 16, v146
  v_and_b32 v37, s57, v146
  v_lshlrev_b32 v38, 16, v147
  v_and_b32 v39, s57, v147
  v_pk_mul_f32 v[16:17], v[32:33], v[40:41] op_sel:[0,0] op_sel_hi:[1,0]
  v_pk_mul_f32 v[18:19], v[34:35], v[40:41] op_sel:[0,0] op_sel_hi:[1,0]
  v_pk_mul_f32 v[20:21], v[36:37], v[40:41] op_sel:[0,0] op_sel_hi:[1,0]
  v_pk_mul_f32 v[22:23], v[38:39], v[40:41] op_sel:[0,0] op_sel_hi:[1,0]
  v_lshlrev_b32 v32, 16, v148
  v_and_b32 v33, s57, v148
  v_lshlrev_b32 v34, 16, v149
  v_and_b32 v35, s57, v149
  v_lshlrev_b32 v36, 16, v150
  v_and_b32 v37, s57, v150
  v_lshlrev_b32 v38, 16, v151
  v_and_b32 v39, s57, v151
  v_pk_fma_f32 v[16:17], v[32:33], v[40:41], v[16:17] op_sel:[0,1,0] op_sel_hi:[1,1,1]
  v_pk_fma_f32 v[18:19], v[34:35], v[40:41], v[18:19] op_sel:[0,1,0] op_sel_hi:[1,1,1]
  v_pk_fma_f32 v[20:21], v[36:37], v[40:41], v[20:21] op_sel:[0,1,0] op_sel_hi:[1,1,1]
  v_pk_fma_f32 v[22:23], v[38:39], v[40:41], v[22:23] op_sel:[0,1,0] op_sel_hi:[1,1,1]
  v_lshlrev_b32 v32, 16, v152
  v_and_b32 v33, s57, v152
  v_lshlrev_b32 v34, 16, v153
  v_and_b32 v35, s57, v153
  v_lshlrev_b32 v36, 16, v154
  v_and_b32 v37, s57, v154
  v_lshlrev_b32 v38, 16, v155
  v_and_b32 v39, s57, v155
  v_pk_fma_f32 v[16:17], v[32:33], v[42:43], v[16:17] op_sel:[0,0,0] op_sel_hi:[1,0,1]
  v_pk_fma_f32 v[18:19], v[34:35], v[42:43], v[18:19] op_sel:[0,0,0] op_sel_hi:[1,0,1]
  v_pk_fma_f32 v[20:21], v[36:37], v[42:43], v[20:21] op_sel:[0,0,0] op_sel_hi:[1,0,1]
  v_pk_fma_f32 v[22:23], v[38:39], v[42:43], v[22:23] op_sel:[0,0,0] op_sel_hi:[1,0,1]
  v_lshlrev_b32 v32, 16, v156
  v_and_b32 v33, s57, v156
  v_lshlrev_b32 v34, 16, v157
  v_and_b32 v35, s57, v157
  v_lshlrev_b32 v36, 16, v158
  v_and_b32 v37, s57, v158
  v_lshlrev_b32 v38, 16, v159
  v_and_b32 v39, s57, v159
  v_pk_fma_f32 v[16:17], v[32:33], v[42:43], v[16:17] op_sel:[0,1,0] op_sel_hi:[1,1,1]
  v_pk_fma_f32 v[18:19], v[34:35], v[42:43], v[18:19] op_sel:[0,1,0] op_sel_hi:[1,1,1]
  v_pk_fma_f32 v[20:21], v[36:37], v[42:43], v[20:21] op_sel:[0,1,0] op_sel_hi:[1,1,1]
  v_pk_fma_f32 v[22:23], v[38:39], v[42:43], v[22:23] op_sel:[0,1,0] op_sel_hi:[1,1,1]
  v_lshlrev_b32 v32, 16, v160
  v_and_b32 v33, s57, v160
  v_lshlrev_b32 v34, 16, v161
  v_and_b32 v35, s57, v161
  v_lshlrev_b32 v36, 16, v162
  v_and_b32 v37, s57, v162
  v_lshlrev_b32 v38, 16, v163
  v_and_b32 v39, s57, v163
  v_pk_fma_f32 v[16:17], v[32:33], v[44:45], v[16:17] op_sel:[0,0,0] op_sel_hi:[1,0,1]
  v_pk_fma_f32 v[18:19], v[34:35], v[44:45], v[18:19] op_sel:[0,0,0] op_sel_hi:[1,0,1]
  v_pk_fma_f32 v[20:21], v[36:37], v[44:45], v[20:21] op_sel:[0,0,0] op_sel_hi:[1,0,1]
  v_pk_fma_f32 v[22:23], v[38:39], v[44:45], v[22:23] op_sel:[0,0,0] op_sel_hi:[1,0,1]
  s_nop 0
  v_permlane32_swap_b32 v16, v20
  v_permlane32_swap_b32 v17, v21
  v_permlane32_swap_b32 v18, v22
  v_permlane32_swap_b32 v19, v23
  v_add_f32 v16, v16, v20
  v_add_f32 v17, v17, v21
  v_add_f32 v18, v18, v22
  v_add_f32 v19, v19, v23
  s_nop 0
  v_permlane16_swap_b32 v16, v18
  v_permlane16_swap_b32 v17, v19
  v_add_f32 v16, v16, v18
  v_add_f32 v17, v17, v19
  s_lshl_b32 s60, s3, 9
  v_add_u32 v1, s60, v5
  ds_write_b64 v1, v[16:17] offset:1280
  v_mov_b32 v1, 1
  s_waitcnt lgkmcnt(0)
  s_mov_b64 exec, 1
  ds_add_rtn_u32 v1, v7, v1 offset:0
  s_waitcnt lgkmcnt(0)
  v_readfirstlane_b32 s60, v1
  s_mov_b64 exec, -1
  s_cmp_lg_u32 s60, 7
  s_cbranch_scc1 L_notlast
L_tagw:
  ds_read_b32 v32, v7 offset:12
  s_waitcnt lgkmcnt(0)
  v_readfirstlane_b32 s93, v32
  s_nop 0
  s_cmp_lg_u32 s93, 0
  s_cbranch_scc1 L_tagw_done
  s_sleep 1
  s_sub_u32 s61, s61, 1
  s_cbranch_scc0 L_tagw
L_tagw_done:
  v_mov_b32 v33, 0xff
  v_and_b32 v1, 31, v0
  v_lshlrev_b32 v1, 4, v1
  v_lshrrev_b32 v16, 5, v0
  v_lshl_add_u32 v1, v16, 11, v1
  ds_read_b128 v[16:19], v1 offset:1280
  ds_read_b128 v[20:23], v1 offset:1792
  ds_read_b128 v[24:27], v1 offset:2304
  ds_read_b128 v[28:31], v1 offset:2816
  s_lshl_b32 s60, s56, 10
  v_add_u32 v1, s60, v2
  s_waitcnt lgkmcnt(0)
  v_add_f32 v16, v16, v20
  v_add_f32 v24, v24, v28
  v_add_f32 v17, v17, v21
  v_add_f32 v25, v25, v29
  v_add_f32 v18, v18, v22
  v_add_f32 v26, v26, v30
  v_add_f32 v19, v19, v23
  v_add_f32 v27, v27, v31
  v_add_f32 v16, v16, v24
  v_add_f32 v17, v17, v25
  v_add_f32 v18, v18, v26
  v_add_f32 v19, v19, v27
  v_bfi_b32 v16, v33, s93, v16
  v_bfi_b32 v17, v33, s93, v17
  v_bfi_b32 v18, v33, s93, v18
  v_bfi_b32 v19, v33, s93, v19
  global_store_dwordx4 v1, v[16:19], s[28:29] sc1
L_notlast:
  s_waitcnt vmcnt(3)
  s_add_u32 s67, s66, 0
  buffer_load_dwordx4 v[80:83], v2, s[40:43], s67 offen nt
  s_waitcnt vmcnt(3)
  s_add_u32 s67, s66, 8192
  buffer_load_dwordx4 v[84:87], v2, s[40:43], s67 offen nt
  s_waitcnt vmcnt(3)
  s_add_u32 s67, s66, 16384
  buffer_load_dwordx4 v[88:91], v2, s[40:43], s67 offen nt
  s_waitcnt vmcnt(3)
  s_add_u32 s67, s66, 24576
  buffer_load_dwordx4 v[92:95], v2, s[40:43], s67 offen nt
  s_waitcnt vmcnt(3)
  s_add_u32 s67, s66, 32768
  buffer_load_dwordx4 v[96:99], v2, s[40:43], s67 offen nt
  s_waitcnt vmcnt(3)
  s_add_u32 s67, s66, 40960
  buffer_load_dwordx4 v[100:103], v2, s[40:43], s67 offen nt
  s_cmp_lg_u32 s3, 0
  s_cbranch_scc1 L_pg0
  v_mov_b32 v37, -72
  ds_write_b32 v7, v37 offset:16
L_pg0:
  s_waitcnt vmcnt(3)
  s_add_u32 s67, s66, 49152
  buffer_load_dwordx4 v[104:107], v2, s[40:43], s67 offen nt
  s_waitcnt vmcnt(3)
  s_add_u32 s67, s66, 57344
  buffer_load_dwordx4 v[108:111], v2, s[40:43], s67 offen nt
  s_cmp_lg_u32 s3, 0
  s_cbranch_scc1 L_pg1
  v_mov_b32 v37, -64
  ds_write_b32 v7, v37 offset:16
L_pg1:
  s_waitcnt vmcnt(3)
  s_add_u32 s67, s65, 0
  buffer_load_dwordx4 v[112:115], v2, s[36:39], s67 offen nt
  s_waitcnt vmcnt(3)
  s_add_u32 s67, s65, 8192
  buffer_load_dwordx4 v[116:119], v2, s[36:39], s67 offen nt
  s_cmp_lg_u32 s3, 0
  s_cbranch_scc1 L_pg2
  v_mov_b32 v37, -56
  ds_write_b32 v7, v37 offset:16
L_pg2:
  s_waitcnt vmcnt(3)
  s_add_u32 s67, s65, 16384
  buffer_load_dwordx4 v[120:123], v2, s[36:39], s67 offen nt
  s_waitcnt vmcnt(3)
  s_add_u32 s67, s65, 24576
  buffer_load_dwordx4 v[124:127], v2, s[36:39], s67 offen nt
  s_cmp_lg_u32 s3, 0
  s_cbranch_scc1 L_pg3
  v_mov_b32 v37, -48
  ds_write_b32 v7, v37 offset:16
L_pg3:
  s_waitcnt vmcnt(3)
  s_add_u32 s67, s66, 0
  buffer_load_dwordx4 v[128:131], v2, s[44:47], s67 offen nt
  s_waitcnt vmcnt(3)
  s_add_u32 s67, s66, 8192
  buffer_load_dwordx4 v[132:135], v2, s[44:47], s67 offen nt
  s_cmp_lg_u32 s3, 0
  s_cbranch_scc1 L_pg4
  v_mov_b32 v37, -40
  ds_write_b32 v7, v37 offset:16
L_pg4:
  s_waitcnt vmcnt(3)
  s_add_u32 s67, s66, 16384
  buffer_load_dwordx4 v[136:139], v2, s[44:47], s67 offen nt
  s_waitcnt vmcnt(3)
  s_add_u32 s67, s66, 24576
  buffer_load_dwordx4 v[140:143], v2, s[44:47], s67 offen nt
  s_cmp_lg_u32 s3, 0
  s_cbranch_scc1 L_pg5
  v_mov_b32 v37, -32
  ds_write_b32 v7, v37 offset:16
L_pg5:
  s_waitcnt vmcnt(3)
  s_add_u32 s67, s66, 32768
  buffer_load_dwordx4 v[144:147], v2, s[44:47], s67 offen nt
L_wq:
  ds_read_b32 v1, v7 offset:8
  s_waitcnt lgkmcnt(0)
  v_readfirstlane_b32 s60, v1
  s_nop 0
  s_cmp_eq_u32 s60, 1
  s_cbranch_scc1 L_wq_done
  s_sleep 1
  s_sub_u32 s61, s61, 1
  s_cbranch_scc0 L_wq
L_wq_done:
  ds_read_b128 v[8:11], v6 offset:256
  ds_read_b128 v[12:15], v6 offset:512
  s_waitcnt lgkmcnt(0)
  v_dot2_f32_bf16 v40, v64, v8, 0
  v_dot2_f32_bf16 v41, v68, v8, 0
  v_dot2_f32_bf16 v42, v72, v8, 0
  v_dot2_f32_bf16 v43, v76, v8, 0
  v_dot2_f32_bf16 v40, v65, v9, v40
  v_dot2_f32_bf16 v41, v69, v9, v41
  v_dot2_f32_bf16 v42, v73, v9, v42
  v_dot2_f32_bf16 v43, v77, v9, v43
  v_dot2_f32_bf16 v40, v66, v10, v40
  v_dot2_f32_bf16 v41, v70, v10, v41
  v_dot2_f32_bf16 v42, v74, v10, v42
  v_dot2_f32_bf16 v43, v78, v10, v43
  v_dot2_f32_bf16 v40, v67, v11, v40
  v_dot2_f32_bf16 v41, v71, v11, v41
  v_dot2_f32_bf16 v42, v75, v11, v42
  v_dot2_f32_bf16 v43, v79, v11, v43
  v_add_f32_dpp v40, v40, v40 row_ror:8 row_mask:0xf bank_mask:0xf
  v_add_f32_dpp v41, v41, v41 row_ror:8 row_mask:0xf bank_mask:0xf
  v_add_f32_dpp v42, v42, v42 row_ror:8 row_mask:0xf bank_mask:0xf
  v_add_f32_dpp v43, v43, v43 row_ror:8 row_mask:0xf bank_mask:0xf
  v_add_f32_dpp v40, v40, v40 row_ror:4 row_mask:0xf bank_mask:0xf
  v_add_f32_dpp v41, v41, v41 row_ror:4 row_mask:0xf bank_mask:0xf
  v_add_f32_dpp v42, v42, v42 row_ror:4 row_mask:0xf bank_mask:0xf
  v_add_f32_dpp v43, v43, v43 row_ror:4 row_mask:0xf bank_mask:0xf
  v_add_f32_dpp v40, v40, v40 row_ror:2 row_mask:0xf bank_mask:0xf
  v_add_f32_dpp v41, v41, v41 row_ror:2 row_mask:0xf bank_mask:0xf
  v_add_f32_dpp v42, v42, v42 row_ror:2 row_mask:0xf bank_mask:0xf
  v_add_f32_dpp v43, v43, v43 row_ror:2 row_mask:0xf bank_mask:0xf
  v_add_f32_dpp v40, v40, v40 row_ror:1 row_mask:0xf bank_mask:0xf
  v_add_f32_dpp v41, v41, v41 row_ror:1 row_mask:0xf bank_mask:0xf
  v_add_f32_dpp v42, v42, v42 row_ror:1 row_mask:0xf bank_mask:0xf
  v_add_f32_dpp v43, v43, v43 row_ror:1 row_mask:0xf bank_mask:0xf
  v_max3_f32 v60, v40, v41, v42
  v_max_f32 v60, v60, v43
  v_mov_b32 v32, v60
  s_nop 1
  v_permlane32_swap_b32 v60, v32
  v_max_f32 v60, v60, v32
  v_mov_b32 v32, v60
  s_nop 1
  v_permlane16_swap_b32 v60, v32
  v_max_f32 v60, v60, v32
  v_mul_f32 v33, s58, v60
  v_fma_f32 v40, v40, s58, -v33
  v_fma_f32 v41, v41, s58, -v33
  v_fma_f32 v42, v42, s58, -v33
  v_fma_f32 v43, v43, s58, -v33
  v_exp_f32 v40, v40
  v_exp_f32 v41, v41
  v_exp_f32 v42, v42
  v_exp_f32 v43, v43
  v_add_f32 v62, v40, v41
  v_add_f32 v62, v62, v42
  v_add_f32 v62, v62, v43
  v_mov_b32 v32, v62
  s_nop 1
  v_permlane32_swap_b32 v62, v32
  v_add_f32 v62, v62, v32
  v_mov_b32 v32, v62
  s_nop 1
  v_permlane16_swap_b32 v62, v32
  v_add_f32 v62, v62, v32
  v_mov_b32 v34, v60
  v_mov_b32 v35, v62
  s_lshl_b32 s60, s3, 4
  v_mov_b32 v36, s60
  s_and_b64 exec, s[90:91], 1
  ds_write_b64 v36, v[34:35] offset:64
  s_and_b64 exec, s[90:91], -1
  v_lshlrev_b32 v32, 16, v112
  v_and_b32 v33, s57, v112
  v_lshlrev_b32 v34, 16, v113
  v_and_b32 v35, s57, v113
  v_lshlrev_b32 v36, 16, v114
  v_and_b32 v37, s57, v114
  v_lshlrev_b32 v38, 16, v115
  v_and_b32 v39, s57, v115
  v_pk_mul_f32 v[16:17], v[32:33], v[40:41] op_sel:[0,0] op_sel_hi:[1,0]
  v_pk_mul_f32 v[18:19], v[34:35], v[40:41] op_sel:[0,0] op_sel_hi:[1,0]
  v_pk_mul_f32 v[20:21], v[36:37], v[40:41] op_sel:[0,0] op_sel_hi:[1,0]
  v_pk_mul_f32 v[22:23], v[38:39], v[40:41] op_sel:[0,0] op_sel_hi:[1,0]
  v_lshlrev_b32 v32, 16, v116
  v_and_b32 v33, s57, v116
  v_lshlrev_b32 v34, 16, v117
  v_and_b32 v35, s57, v117
  v_lshlrev_b32 v36, 16, v118
  v_and_b32 v37, s57, v118
  v_lshlrev_b32 v38, 16, v119
  v_and_b32 v39, s57, v119
  v_pk_fma_f32 v[16:17], v[32:33], v[40:41], v[16:17] op_sel:[0,1,0] op_sel_hi:[1,1,1]
  v_pk_fma_f32 v[18:19], v[34:35], v[40:41], v[18:19] op_sel:[0,1,0] op_sel_hi:[1,1,1]
  v_pk_fma_f32 v[20:21], v[36:37], v[40:41], v[20:21] op_sel:[0,1,0] op_sel_hi:[1,1,1]
  v_pk_fma_f32 v[22:23], v[38:39], v[40:41], v[22:23] op_sel:[0,1,0] op_sel_hi:[1,1,1]
  s_waitcnt vmcnt(3)
  s_add_u32 s67, s66, 40960
  buffer_load_dwordx4 v[148:151], v2, s[44:47], s67 offen nt
  v_dot2_f32_bf16 v44, v80, v12, 0
  v_dot2_f32_bf16 v45, v84, v12, 0
  v_dot2_f32_bf16 v46, v88, v12, 0
  v_dot2_f32_bf16 v47, v92, v12, 0
  v_dot2_f32_bf16 v44, v81, v13, v44
  v_dot2_f32_bf16 v45, v85, v13, v45
  v_dot2_f32_bf16 v46, v89, v13, v46
  v_dot2_f32_bf16 v47, v93, v13, v47
  v_dot2_f32_bf16 v44, v82, v14, v44
  v_dot2_f32_bf16 v45, v86, v14, v45
  v_dot2_f32_bf16 v46, v90, v14, v46
  v_dot2_f32_bf16 v47, v94, v14, v47
  v_dot2_f32_bf16 v44, v83, v15, v44
  v_dot2_f32_bf16 v45, v87, v15, v45
  v_dot2_f32_bf16 v46, v91, v15, v46
  v_dot2_f32_bf16 v47, v95, v15, v47
  v_add_f32_dpp v44, v44, v44 row_ror:8 row_mask:0xf bank_mask:0xf
  v_add_f32_dpp v45, v45, v45 row_ror:8 row_mask:0xf bank_mask:0xf
  v_add_f32_dpp v46, v46, v46 row_ror:8 row_mask:0xf bank_mask:0xf
  v_add_f32_dpp v47, v47, v47 row_ror:8 row_mask:0xf bank_mask:0xf
  v_add_f32_dpp v44, v44, v44 row_ror:4 row_mask:0xf bank_mask:0xf
  v_add_f32_dpp v45, v45, v45 row_ror:4 row_mask:0xf bank_mask:0xf
  v_add_f32_dpp v46, v46, v46 row_ror:4 row_mask:0xf bank_mask:0xf
  v_add_f32_dpp v47, v47, v47 row_ror:4 row_mask:0xf bank_mask:0xf
  v_add_f32_dpp v44, v44, v44 row_ror:2 row_mask:0xf bank_mask:0xf
  v_add_f32_dpp v45, v45, v45 row_ror:2 row_mask:0xf bank_mask:0xf
  v_add_f32_dpp v46, v46, v46 row_ror:2 row_mask:0xf bank_mask:0xf
  v_add_f32_dpp v47, v47, v47 row_ror:2 row_mask:0xf bank_mask:0xf
  v_add_f32_dpp v44, v44, v44 row_ror:1 row_mask:0xf bank_mask:0xf
  v_add_f32_dpp v45, v45, v45 row_ror:1 row_mask:0xf bank_mask:0xf
  v_add_f32_dpp v46, v46, v46 row_ror:1 row_mask:0xf bank_mask:0xf
  v_add_f32_dpp v47, v47, v47 row_ror:1 row_mask:0xf bank_mask:0xf
  v_lshlrev_b32 v32, 16, v120
  v_and_b32 v33, s57, v120
  v_lshlrev_b32 v34, 16, v121
  v_and_b32 v35, s57, v121
  v_lshlrev_b32 v36, 16, v122
  v_and_b32 v37, s57, v122
  v_lshlrev_b32 v38, 16, v123
  v_and_b32 v39, s57, v123
  v_pk_fma_f32 v[16:17], v[32:33], v[42:43], v[16:17] op_sel:[0,0,0] op_sel_hi:[1,0,1]
  v_pk_fma_f32 v[18:19], v[34:35], v[42:43], v[18:19] op_sel:[0,0,0] op_sel_hi:[1,0,1]
  v_pk_fma_f32 v[20:21], v[36:37], v[42:43], v[20:21] op_sel:[0,0,0] op_sel_hi:[1,0,1]
  v_pk_fma_f32 v[22:23], v[38:39], v[42:43], v[22:23] op_sel:[0,0,0] op_sel_hi:[1,0,1]
  v_lshlrev_b32 v32, 16, v124
  v_and_b32 v33, s57, v124
  v_lshlrev_b32 v34, 16, v125
  v_and_b32 v35, s57, v125
  v_lshlrev_b32 v36, 16, v126
  v_and_b32 v37, s57, v126
  v_lshlrev_b32 v38, 16, v127
  v_and_b32 v39, s57, v127
  v_pk_fma_f32 v[16:17], v[32:33], v[42:43], v[16:17] op_sel:[0,1,0] op_sel_hi:[1,1,1]
  v_pk_fma_f32 v[18:19], v[34:35], v[42:43], v[18:19] op_sel:[0,1,0] op_sel_hi:[1,1,1]
  v_pk_fma_f32 v[20:21], v[36:37], v[42:43], v[20:21] op_sel:[0,1,0] op_sel_hi:[1,1,1]
  v_pk_fma_f32 v[22:23], v[38:39], v[42:43], v[22:23] op_sel:[0,1,0] op_sel_hi:[1,1,1]
  s_cmp_lg_u32 s3, 0
  s_cbranch_scc1 L_pg6
  v_mov_b32 v37, -24
  ds_write_b32 v7, v37 offset:16
L_pg6:
  s_waitcnt vmcnt(3)
  s_add_u32 s67, s66, 49152
  buffer_load_dwordx4 v[152:155], v2, s[44:47], s67 offen nt
  v_dot2_f32_bf16 v48, v96, v12, 0
  v_dot2_f32_bf16 v49, v100, v12, 0
  v_dot2_f32_bf16 v50, v104, v12, 0
  v_dot2_f32_bf16 v51, v108, v12, 0
  v_dot2_f32_bf16 v48, v97, v13, v48
  v_dot2_f32_bf16 v49, v101, v13, v49
  v_dot2_f32_bf16 v50, v105, v13, v50
  v_dot2_f32_bf16 v51, v109, v13, v51
  v_dot2_f32_bf16 v48, v98, v14, v48
  v_dot2_f32_bf16 v49, v102, v14, v49
  v_dot2_f32_bf16 v50, v106, v14, v50
  v_dot2_f32_bf16 v51, v110, v14, v51
  v_dot2_f32_bf16 v48, v99, v15, v48
  v_dot2_f32_bf16 v49, v103, v15, v49
  v_dot2_f32_bf16 v50, v107, v15, v50
  v_dot2_f32_bf16 v51, v111, v15, v51
  v_add_f32_dpp v48, v48, v48 row_ror:8 row_mask:0xf bank_mask:0xf
  v_add_f32_dpp v49, v49, v49 row_ror:8 row_mask:0xf bank_mask:0xf
  v_add_f32_dpp v50, v50, v50 row_ror:8 row_mask:0xf bank_mask:0xf
  v_add_f32_dpp v51, v51, v51 row_ror:8 row_mask:0xf bank_mask:0xf
  v_add_f32_dpp v48, v48, v48 row_ror:4 row_mask:0xf bank_mask:0xf
  v_add_f32_dpp v49, v49, v49 row_ror:4 row_mask:0xf bank_mask:0xf
  v_add_f32_dpp v50, v50, v50 row_ror:4 row_mask:0xf bank_mask:0xf
  v_add_f32_dpp v51, v51, v51 row_ror:4 row_mask:0xf bank_mask:0xf
  v_add_f32_dpp v48, v48, v48 row_ror:2 row_mask:0xf bank_mask:0xf
  v_add_f32_dpp v49, v49, v49 row_ror:2 row_mask:0xf bank_mask:0xf
  v_add_f32_dpp v50, v50, v50 row_ror:2 row_mask:0xf bank_mask:0xf
  v_add_f32_dpp v51, v51, v51 row_ror:2 row_mask:0xf bank_mask:0xf
  v_add_f32_dpp v48, v48, v48 row_ror:1 row_mask:0xf bank_mask:0xf
  v_add_f32_dpp v49, v49, v49 row_ror:1 row_mask:0xf bank_mask:0xf
  v_add_f32_dpp v50, v50, v50 row_ror:1 row_mask:0xf bank_mask:0xf
  v_add_f32_dpp v51, v51, v51 row_ror:1 row_mask:0xf bank_mask:0xf
  v_max3_f32 v61, v44, v45, v46
  v_max3_f32 v61, v61, v47, v48
  v_max3_f32 v61, v61, v49, v50
  v_max_f32 v61, v61, v51
  v_mul_f32 v33, s58, v61
  v_fma_f32 v44, v44, s58, -v33
  v_fma_f32 v45, v45, s58, -v33
  v_fma_f32 v46, v46, s58, -v33
  v_fma_f32 v47, v47, s58, -v33
  v_fma_f32 v48, v48, s58, -v33
  v_fma_f32 v49, v49, s58, -v33
  v_fma_f32 v50, v50, s58, -v33
  v_fma_f32 v51, v51, s58, -v33
  v_exp_f32 v44, v44
  v_exp_f32 v45, v45
  v_exp_f32 v46, v46
  v_exp_f32 v47, v47
  v_exp_f32 v48, v48
  v_exp_f32 v49, v49
  v_exp_f32 v50, v50
  v_exp_f32 v51, v51
  v_add_f32 v63, v44, v45
  v_add_f32 v63, v63, v46
  v_add_f32 v63, v63, v47
  v_add_f32 v63, v63, v48
  v_add_f32 v63, v63, v49
  v_add_f32 v63, v63, v50
  v_add_f32 v63, v63, v51
  v_lshlrev_b32 v32, 16, v128
  v_and_b32 v33, s57, v128
  v_lshlrev_b32 v34, 16, v129
  v_and_b32 v35, s57, v129
  v_lshlrev_b32 v36, 16, v130
  v_and_b32 v37, s57, v130
  v_lshlrev_b32 v38, 16, v131
  v_and_b32 v39, s57, v131
  v_pk_mul_f32 v[24:25], v[32:33], v[44:45] op_sel:[0,0] op_sel_hi:[1,0]
  v_pk_mul_f32 v[26:27], v[34:35], v[44:45] op_sel:[0,0] op_sel_hi:[1,0]
  v_pk_mul_f32 v[28:29], v[36:37], v[44:45] op_sel:[0,0] op_sel_hi:[1,0]
  v_pk_mul_f32 v[30:31], v[38:39], v[44:45] op_sel:[0,0] op_sel_hi:[1,0]
  v_lshlrev_b32 v32, 16, v132
  v_and_b32 v33, s57, v132
  v_lshlrev_b32 v34, 16, v133
  v_and_b32 v35, s57, v133
  v_lshlrev_b32 v36, 16, v134
  v_and_b32 v37, s57, v134
  v_lshlrev_b32 v38, 16, v135
  v_and_b32 v39, s57, v135
  v_pk_fma_f32 v[24:25], v[32:33], v[44:45], v[24:25] op_sel:[0,1,0] op_sel_hi:[1,1,1]
  v_pk_fma_f32 v[26:27], v[34:35], v[44:45], v[26:27] op_sel:[0,1,0] op_sel_hi:[1,1,1]
  v_pk_fma_f32 v[28:29], v[36:37], v[44:45], v[28:29] op_sel:[0,1,0] op_sel_hi:[1,1,1]
  v_pk_fma_f32 v[30:31], v[38:39], v[44:45], v[30:31] op_sel:[0,1,0] op_sel_hi:[1,1,1]
  s_waitcnt vmcnt(3)
  s_add_u32 s67, s66, 57344
  buffer_load_dwordx4 v[156:159], v2, s[44:47], s67 offen nt
  v_lshlrev_b32 v32, 16, v136
  v_and_b32 v33, s57, v136
  v_lshlrev_b32 v34, 16, v137
  v_and_b32 v35, s57, v137
  v_lshlrev_b32 v36, 16, v138
  v_and_b32 v37, s57, v138
  v_lshlrev_b32 v38, 16, v139
  v_and_b32 v39, s57, v139
  v_pk_fma_f32 v[24:25], v[32:33], v[46:47], v[24:25] op_sel:[0,0,0] op_sel_hi:[1,0,1]
  v_pk_fma_f32 v[26:27], v[34:35], v[46:47], v[26:27] op_sel:[0,0,0] op_sel_hi:[1,0,1]
  v_pk_fma_f32 v[28:29], v[36:37], v[46:47], v[28:29] op_sel:[0,0,0] op_sel_hi:[1,0,1]
  v_pk_fma_f32 v[30:31], v[38:39], v[46:47], v[30:31] op_sel:[0,0,0] op_sel_hi:[1,0,1]
  v_lshlrev_b32 v32, 16, v140
  v_and_b32 v33, s57, v140
  v_lshlrev_b32 v34, 16, v141
  v_and_b32 v35, s57, v141
  v_lshlrev_b32 v36, 16, v142
  v_and_b32 v37, s57, v142
  v_lshlrev_b32 v38, 16, v143
  v_and_b32 v39, s57, v143
  v_pk_fma_f32 v[24:25], v[32:33], v[46:47], v[24:25] op_sel:[0,1,0] op_sel_hi:[1,1,1]
  v_pk_fma_f32 v[26:27], v[34:35], v[46:47], v[26:27] op_sel:[0,1,0] op_sel_hi:[1,1,1]
  v_pk_fma_f32 v[28:29], v[36:37], v[46:47], v[28:29] op_sel:[0,1,0] op_sel_hi:[1,1,1]
  v_pk_fma_f32 v[30:31], v[38:39], v[46:47], v[30:31] op_sel:[0,1,0] op_sel_hi:[1,1,1]
  s_cmp_lg_u32 s3, 0
  s_cbranch_scc1 L_pg7
  v_mov_b32 v37, -16
  ds_write_b32 v7, v37 offset:16
L_pg7:
  s_lshl_b32 s69, s96, 17
  s_add_u32 s69, s69, 0
  s_add_u32 s69, s69, s64
  s_waitcnt vmcnt(3)
  buffer_load_dwordx4 v[160:163], v2, s[40:43], s69 offen nt
  v_lshlrev_b32 v32, 16, v144
  v_and_b32 v33, s57, v144
  v_lshlrev_b32 v34, 16, v145
  v_and_b32 v35, s57, v145
  v_lshlrev_b32 v36, 16, v146
  v_and_b32 v37, s57, v146
  v_lshlrev_b32 v38, 16, v147
  v_and_b32 v39, s57, v147
  v_pk_fma_f32 v[24:25], v[32:33], v[48:49], v[24:25] op_sel:[0,0,0] op_sel_hi:[1,0,1]
  v_pk_fma_f32 v[26:27], v[34:35], v[48:49], v[26:27] op_sel:[0,0,0] op_sel_hi:[1,0,1]
  v_pk_fma_f32 v[28:29], v[36:37], v[48:49], v[28:29] op_sel:[0,0,0] op_sel_hi:[1,0,1]
  v_pk_fma_f32 v[30:31], v[38:39], v[48:49], v[30:31] op_sel:[0,0,0] op_sel_hi:[1,0,1]
  s_waitcnt vmcnt(3)
  buffer_load_dwordx4 v[164:167], v2, s[44:47], s69 offen nt
  v_lshlrev_b32 v32, 16, v148
  v_and_b32 v33, s57, v148
  v_lshlrev_b32 v34, 16, v149
  v_and_b32 v35, s57, v149
  v_lshlrev_b32 v36, 16, v150
  v_and_b32 v37, s57, v150
  v_lshlrev_b32 v38, 16, v151
  v_and_b32 v39, s57, v151
  v_pk_fma_f32 v[24:25], v[32:33], v[48:49], v[24:25] op_sel:[0,1,0] op_sel_hi:[1,1,1]
  v_pk_fma_f32 v[26:27], v[34:35], v[48:49], v[26:27] op_sel:[0,1,0] op_sel_hi:[1,1,1]
  v_pk_fma_f32 v[28:29], v[36:37], v[48:49], v[28:29] op_sel:[0,1,0] op_sel_hi:[1,1,1]
  v_pk_fma_f32 v[30:31], v[38:39], v[48:49], v[30:31] op_sel:[0,1,0] op_sel_hi:[1,1,1]
  s_cmp_lg_u32 s3, 0
  s_cbranch_scc1 L_pg8
  v_mov_b32 v37, -8
  ds_write_b32 v7, v37 offset:16
L_pg8:
  s_lshl_b32 s69, s96, 17
  s_add_u32 s69, s69, 8192
  s_add_u32 s69, s69, s64
  s_waitcnt vmcnt(3)
  buffer_load_dwordx4 v[64:67], v2, s[40:43], s69 offen nt
  v_lshlrev_b32 v32, 16, v152
  v_and_b32 v33, s57, v152
  v_lshlrev_b32 v34, 16, v153
  v_and_b32 v35, s57, v153
  v_lshlrev_b32 v36, 16, v154
  v_and_b32 v37, s57, v154
  v_lshlrev_b32 v38, 16, v155
  v_and_b32 v39, s57, v155
  v_pk_fma_f32 v[24:25], v[32:33], v[50:51], v[24:25] op_sel:[0,0,0] op_sel_hi:[1,0,1]
  v_pk_fma_f32 v[26:27], v[34:35], v[50:51], v[26:27] op_sel:[0,0,0] op_sel_hi:[1,0,1]
  v_pk_fma_f32 v[28:29], v[36:37], v[50:51], v[28:29] op_sel:[0,0,0] op_sel_hi:[1,0,1]
  v_pk_fma_f32 v[30:31], v[38:39], v[50:51], v[30:31] op_sel:[0,0,0] op_sel_hi:[1,0,1]
  s_waitcnt vmcnt(3)
  buffer_load_dwordx4 v[68:71], v2, s[44:47], s69 offen nt
  v_lshlrev_b32 v32, 16, v156
  v_and_b32 v33, s57, v156
  v_lshlrev_b32 v34, 16, v157
  v_and_b32 v35, s57, v157
  v_lshlrev_b32 v36, 16, v158
  v_and_b32 v37, s57, v158
  v_lshlrev_b32 v38, 16, v159
  v_and_b32 v39, s57, v159
  v_pk_fma_f32 v[24:25], v[32:33], v[50:51], v[24:25] op_sel:[0,1,0] op_sel_hi:[1,1,1]
  v_pk_fma_f32 v[26:27], v[34:35], v[50:51], v[26:27] op_sel:[0,1,0] op_sel_hi:[1,1,1]
  v_pk_fma_f32 v[28:29], v[36:37], v[50:51], v[28:29] op_sel:[0,1,0] op_sel_hi:[1,1,1]
  v_pk_fma_f32 v[30:31], v[38:39], v[50:51], v[30:31] op_sel:[0,1,0] op_sel_hi:[1,1,1]
  v_mov_b32 v58, 1
  s_lshl_b32 s97, s3, 10
  s_sub_u32 s97, s64, s97
  s_cmp_lg_u32 s3, 0
  s_cbranch_scc1 L_pg9
  v_mov_b32 v37, 0
  ds_write_b32 v7, v37 offset:16
L_pg9:
  s_mov_b64 exec, 1
  ds_add_rtn_u32 v52, v7, v58 offset:20
  s_mov_b64 exec, -1
  s_waitcnt lgkmcnt(0)
  v_readfirstlane_b32 s68, v52
  s_nop 0
  s_lshr_b32 s60, s68, 3
  s_min_u32 s60, s60, 127
  s_lshl_b32 s60, s60, 2
  v_mov_b32 v53, s60
  ds_read_b32 v54, v7 offset:4
  ds_read_b32 v55, v53 offset:54528
L_dyn:
L_sd0:
  s_waitcnt lgkmcnt(0)
  v_readfirstlane_b32 s88, v54
  v_readfirstlane_b32 s69, v55
  s_cmp_lg_u32 s88, 0
  s_cbranch_scc1 L_sd0_fin
  s_cmp_lg_u32 s69, -1
  s_cbranch_scc1 L_sd0_got
  s_sleep 1
  ds_read_b32 v54, v7 offset:4
  ds_read_b32 v55, v53 offset:54528
  s_sub_u32 s61, s61, 1
  s_cbranch_scc0 L_sd0
  s_branch L_drain0
L_sd0_fin:
  s_mov_b32 s92, 0
  s_sub_u32 s88, s88, 1
  s_cmp_ge_u32 s68, s88
  s_cbranch_scc1 L_drain0
  s_branch L_fast
L_sd0_got:
  s_and_b32 s60, s68, 7
  s_lshr_b32 s62, s69, 3
  s_lshl_b32 s62, s62, 3
  s_add_u32 s60, s60, s62
  s_and_b32 s69, s69, 7
  s_lshl_b32 s69, s69, 7
  s_add_u32 s69, s69, s60
  s_lshl_b32 s69, s69, 10
  s_add_u32 s69, s69, s97
  s_waitcnt vmcnt(3)
  buffer_load_dwordx4 v[72:75], v2, s[40:43], s69 offen nt
  v_dot2_f32_bf16 v48, v160, v12, 0
  v_dot2_f32_bf16 v48, v161, v13, v48
  v_dot2_f32_bf16 v48, v162, v14, v48
  v_dot2_f32_bf16 v48, v163, v15, v48
  s_nop 2
  v_add_f32_dpp v48, v48, v48 row_ror:8 row_mask:0xf bank_mask:0xf
  s_nop 1
  v_add_f32_dpp v48, v48, v48 row_ror:4 row_mask:0xf bank_mask:0xf
  s_nop 1
  v_add_f32_dpp v48, v48, v48 row_ror:2 row_mask:0xf bank_mask:0xf
  s_nop 1
  v_add_f32_dpp v48, v48, v48 row_ror:1 row_mask:0xf bank_mask:0xf
  v_max_f32 v49, v61, v48
  v_sub_f32 v50, v61, v49
  v_sub_f32 v51, v48, v49
  v_mul_f32 v50, s58, v50
  v_mul_f32 v51, s58, v51
  v_exp_f32 v50, v50
  v_exp_f32 v51, v51
  v_mov_b32 v61, v49
  v_fma_f32 v63, v63, v50, v51
  s_waitcnt vmcnt(3)
  buffer_load_dwordx4 v[76:79], v2, s[44:47], s69 offen nt
  s_mov_b64 exec, 1
  ds_add_rtn_u32 v52, v7, v58 offset:20
  s_mov_b64 exec, -1
  v_lshlrev_b32 v32, 16, v164
  v_and_b32 v33, s57, v164
  v_lshlrev_b32 v34, 16, v165
  v_and_b32 v35, s57, v165
  v_lshlrev_b32 v36, 16, v166
  v_and_b32 v37, s57, v166
  v_lshlrev_b32 v38, 16, v167
  v_and_b32 v39, s57, v167
  v_pk_mul_f32 v[32:33], v[32:33], v[50:51] op_sel:[0,1] op_sel_hi:[1,1]
  v_pk_mul_f32 v[34:35], v[34:35], v[50:51] op_sel:[0,1] op_sel_hi:[1,1]
  v_pk_mul_f32 v[36:37], v[36:37], v[50:51] op_sel:[0,1] op_sel_hi:[1,1]
  v_pk_mul_f32 v[38:39], v[38:39], v[50:51] op_sel:[0,1] op_sel_hi:[1,1]
  v_pk_fma_f32 v[24:25], v[24:25], v[50:51], v[32:33] op_sel:[0,0,0] op_sel_hi:[1,0,1]
  v_pk_fma_f32 v[26:27], v[26:27], v[50:51], v[34:35] op_sel:[0,0,0] op_sel_hi:[1,0,1]
  v_pk_fma_f32 v[28:29], v[28:29], v[50:51], v[36:37] op_sel:[0,0,0] op_sel_hi:[1,0,1]
  v_pk_fma_f32 v[30:31], v[30:31], v[50:51], v[38:39] op_sel:[0,0,0] op_sel_hi:[1,0,1]
  s_waitcnt lgkmcnt(0)
  v_readfirstlane_b32 s68, v52
  s_nop 0
  s_lshr_b32 s60, s68, 3
  s_min_u32 s60, s60, 127
  s_lshl_b32 s60, s60, 2
  v_mov_b32 v53, s60
  ds_read_b32 v54, v7 offset:4
  ds_read_b32 v55, v53 offset:54528
L_sd1:
  s_waitcnt lgkmcnt(0)
  v_readfirstlane_b32 s88, v54
  v_readfirstlane_b32 s69, v55
  s_cmp_lg_u32 s88, 0
  s_cbranch_scc1 L_sd1_fin
  s_cmp_lg_u32 s69, -1
  s_cbranch_scc1 L_sd1_got
  s_sleep 1
  ds_read_b32 v54, v7 offset:4
  ds_read_b32 v55, v53 offset:54528
  s_sub_u32 s61, s61, 1
  s_cbranch_scc0 L_sd1
  s_branch L_drain1
L_sd1_fin:
  s_mov_b32 s92, 1
  s_sub_u32 s88, s88, 1
  s_cmp_ge_u32 s68, s88
  s_cbranch_scc1 L_drain1
  s_branch L_fast
L_sd1_got:
  s_and_b32 s60, s68, 7
  s_lshr_b32 s62, s69, 3
  s_lshl_b32 s62, s62, 3
  s_add_u32 s60, s60, s62
  s_and_b32 s69, s69, 7
  s_lshl_b32 s69, s69, 7
  s_add_u32 s69, s69, s60
  s_lshl_b32 s69, s69, 10
  s_add_u32 s69, s69, s97
  s_waitcnt vmcnt(3)
  buffer_load_dwordx4 v[160:163], v2, s[40:43], s69 offen nt
  v_dot2_f32_bf16 v48, v64, v12, 0
  v_dot2_f32_bf16 v48, v65, v13, v48
  v_dot2_f32_bf16 v48, v66, v14, v48
  v_dot2_f32_bf16 v48, v67, v15, v48
  s_nop 2
  v_add_f32_dpp v48, v48, v48 row_ror:8 row_mask:0xf bank_mask:0xf
  s_nop 1
  v_add_f32_dpp v48, v48, v48 row_ror:4 row_mask:0xf bank_mask:0xf
  s_nop 1
  v_add_f32_dpp v48, v48, v48 row_ror:2 row_mask:0xf bank_mask:0xf
  s_nop 1
  v_add_f32_dpp v48, v48, v48 row_ror:1 row_mask:0xf bank_mask:0xf
  v_max_f32 v49, v61, v48
  v_sub_f32 v50, v61, v49
  v_sub_f32 v51, v48, v49
  v_mul_f32 v50, s58, v50
  v_mul_f32 v51, s58, v51
  v_exp_f32 v50, v50
  v_exp_f32 v51, v51
  v_mov_b32 v61, v49
  v_fma_f32 v63, v63, v50, v51
  s_waitcnt vmcnt(3)
  buffer_load_dwordx4 v[164:167], v2, s[44:47], s69 offen nt
  s_mov_b64 exec, 1
  ds_add_rtn_u32 v52, v7, v58 offset:20
  s_mov_b64 exec, -1
  v_lshlrev_b32 v32, 16, v68
  v_and_b32 v33, s57, v68
  v_lshlrev_b32 v34, 16, v69
  v_and_b32 v35, s57, v69
  v_lshlrev_b32 v36, 16, v70
  v_and_b32 v37, s57, v70
  v_lshlrev_b32 v38, 16, v71
  v_and_b32 v39, s57, v71
  v_pk_mul_f32 v[32:33], v[32:33], v[50:51] op_sel:[0,1] op_sel_hi:[1,1]
  v_pk_mul_f32 v[34:35], v[34:35], v[50:51] op_sel:[0,1] op_sel_hi:[1,1]
  v_pk_mul_f32 v[36:37], v[36:37], v[50:51] op_sel:[0,1] op_sel_hi:[1,1]
  v_pk_mul_f32 v[38:39], v[38:39], v[50:51] op_sel:[0,1] op_sel_hi:[1,1]
  v_pk_fma_f32 v[24:25], v[24:25], v[50:51], v[32:33] op_sel:[0,0,0] op_sel_hi:[1,0,1]
  v_pk_fma_f32 v[26:27], v[26:27], v[50:51], v[34:35] op_sel:[0,0,0] op_sel_hi:[1,0,1]
  v_pk_fma_f32 v[28:29], v[28:29], v[50:51], v[36:37] op_sel:[0,0,0] op_sel_hi:[1,0,1]
  v_pk_fma_f32 v[30:31], v[30:31], v[50:51], v[38:39] op_sel:[0,0,0] op_sel_hi:[1,0,1]
  s_waitcnt lgkmcnt(0)
  v_readfirstlane_b32 s68, v52
  s_nop 0
  s_lshr_b32 s60, s68, 3
  s_min_u32 s60, s60, 127
  s_lshl_b32 s60, s60, 2
  v_mov_b32 v53, s60
  ds_read_b32 v54, v7 offset:4
  ds_read_b32 v55, v53 offset:54528
L_sd2:
  s_waitcnt lgkmcnt(0)
  v_readfirstlane_b32 s88, v54
  v_readfirstlane_b32 s69, v55
  s_cmp_lg_u32 s88, 0
  s_cbranch_scc1 L_sd2_fin
  s_cmp_lg_u32 s69, -1
  s_cbranch_scc1 L_sd2_got
  s_sleep 1
  ds_read_b32 v54, v7 offset:4
  ds_read_b32 v55, v53 offset:54528
  s_sub_u32 s61, s61, 1
  s_cbranch_scc0 L_sd2
  s_branch L_drain2
L_sd2_fin:
  s_mov_b32 s92, 2
  s_sub_u32 s88, s88, 1
  s_cmp_ge_u32 s68, s88
  s_cbranch_scc1 L_drain2
  s_branch L_fast
L_sd2_got:
  s_and_b32 s60, s68, 7
  s_lshr_b32 s62, s69, 3
  s_lshl_b32 s62, s62, 3
  s_add_u32 s60, s60, s62
  s_and_b32 s69, s69, 7
  s_lshl_b32 s69, s69, 7
  s_add_u32 s69, s69, s60
  s_lshl_b32 s69, s69, 10
  s_add_u32 s69, s69, s97
  s_waitcnt vmcnt(3)
  buffer_load_dwordx4 v[64:67], v2, s[40:43], s69 offen nt
  v_dot2_f32_bf16 v48, v72, v12, 0
  v_dot2_f32_bf16 v48, v73, v13, v48
  v_dot2_f32_bf16 v48, v74, v14, v48
  v_dot2_f32_bf16 v48, v75, v15, v48
  s_nop 2
  v_add_f32_dpp v48, v48, v48 row_ror:8 row_mask:0xf bank_mask:0xf
  s_nop 1
  v_add_f32_dpp v48, v48, v48 row_ror:4 row_mask:0xf bank_mask:0xf
  s_nop 1
  v_add_f32_dpp v48, v48, v48 row_ror:2 row_mask:0xf bank_mask:0xf
  s_nop 1
  v_add_f32_dpp v48, v48, v48 row_ror:1 row_mask:0xf bank_mask:0xf
  v_max_f32 v49, v61, v48
  v_sub_f32 v50, v61, v49
  v_sub_f32 v51, v48, v49
  v_mul_f32 v50, s58, v50
  v_mul_f32 v51, s58, v51
  v_exp_f32 v50, v50
  v_exp_f32 v51, v51
  v_mov_b32 v61, v49
  v_fma_f32 v63, v63, v50, v51
  s_waitcnt vmcnt(3)
  buffer_load_dwordx4 v[68:71], v2, s[44:47], s69 offen nt
  s_mov_b64 exec, 1
  ds_add_rtn_u32 v52, v7, v58 offset:20
  s_mov_b64 exec, -1
  v_lshlrev_b32 v32, 16, v76
  v_and_b32 v33, s57, v76
  v_lshlrev_b32 v34, 16, v77
  v_and_b32 v35, s57, v77
  v_lshlrev_b32 v36, 16, v78
  v_and_b32 v37, s57, v78
  v_lshlrev_b32 v38, 16, v79
  v_and_b32 v39, s57, v79
  v_pk_mul_f32 v[32:33], v[32:33], v[50:51] op_sel:[0,1] op_sel_hi:[1,1]
  v_pk_mul_f32 v[34:35], v[34:35], v[50:51] op_sel:[0,1] op_sel_hi:[1,1]
  v_pk_mul_f32 v[36:37], v[36:37], v[50:51] op_sel:[0,1] op_sel_hi:[1,1]
  v_pk_mul_f32 v[38:39], v[38:39], v[50:51] op_sel:[0,1] op_sel_hi:[1,1]
  v_pk_fma_f32 v[24:25], v[24:25], v[50:51], v[32:33] op_sel:[0,0,0] op_sel_hi:[1,0,1]
  v_pk_fma_f32 v[26:27], v[26:27], v[50:51], v[34:35] op_sel:[0,0,0] op_sel_hi:[1,0,1]
  v_pk_fma_f32 v[28:29], v[28:29], v[50:51], v[36:37] op_sel:[0,0,0] op_sel_hi:[1,0,1]
  v_pk_fma_f32 v[30:31], v[30:31], v[50:51], v[38:39] op_sel:[0,0,0] op_sel_hi:[1,0,1]
  s_waitcnt lgkmcnt(0)
  v_readfirstlane_b32 s68, v52
  s_nop 0
  s_lshr_b32 s60, s68, 3
  s_min_u32 s60, s60, 127
  s_lshl_b32 s60, s60, 2
  v_mov_b32 v53, s60
  ds_read_b32 v54, v7 offset:4
  ds_read_b32 v55, v53 offset:54528
  s_branch L_dyn
L_drain0:
  s_cbranch_execz L_gt0
  s_waitcnt vmcnt(3)
L_gt0:
  v_dot2_f32_bf16 v48, v160, v12, 0
  v_dot2_f32_bf16 v48, v161, v13, v48
  v_dot2_f32_bf16 v48, v162, v14, v48
  v_dot2_f32_bf16 v48, v163, v15, v48
  s_nop 2
  v_add_f32_dpp v48, v48, v48 row_ror:8 row_mask:0xf bank_mask:0xf
  s_nop 1
  v_add_f32_dpp v48, v48, v48 row_ror:4 row_mask:0xf bank_mask:0xf
  s_nop 1
  v_add_f32_dpp v48, v48, v48 row_ror:2 row_mask:0xf bank_mask:0xf
  s_nop 1
  v_add_f32_dpp v48, v48, v48 row_ror:1 row_mask:0xf bank_mask:0xf
  v_max_f32 v49, v61, v48
  v_sub_f32 v50, v61, v49
  v_sub_f32 v51, v48, v49
  v_mul_f32 v50, s58, v50
  v_mul_f32 v51, s58, v51
  v_exp_f32 v50, v50
  v_exp_f32 v51, v51
  v_mov_b32 v61, v49
  v_fma_f32 v63, v63, v50, v51
  s_cbranch_execz L_gt1
  s_waitcnt vmcnt(2)
L_gt1:
  v_lshlrev_b32 v32, 16, v164
  v_and_b32 v33, s57, v164
  v_lshlrev_b32 v34, 16, v165
  v_and_b32 v35, s57, v165
  v_lshlrev_b32 v36, 16, v166
  v_and_b32 v37, s57, v166
  v_lshlrev_b32 v38, 16, v167
  v_and_b32 v39, s57, v167
  v_pk_mul_f32 v[32:33], v[32:33], v[50:51] op_sel:[0,1] op_sel_hi:[1,1]
  v_pk_mul_f32 v[34:35], v[34:35], v[50:51] op_sel:[0,1] op_sel_hi:[1,1]
  v_pk_mul_f32 v[36:37], v[36:37], v[50:51] op_sel:[0,1] op_sel_hi:[1,1]
  v_pk_mul_f32 v[38:39], v[38:39], v[50:51] op_sel:[0,1] op_sel_hi:[1,1]
  v_pk_fma_f32 v[24:25], v[24:25], v[50:51], v[32:33] op_sel:[0,0,0] op_sel_hi:[1,0,1]
  v_pk_fma_f32 v[26:27], v[26:27], v[50:51], v[34:35] op_sel:[0,0,0] op_sel_hi:[1,0,1]
  v_pk_fma_f32 v[28:29], v[28:29], v[50:51], v[36:37] op_sel:[0,0,0] op_sel_hi:[1,0,1]
  v_pk_fma_f32 v[30:31], v[30:31], v[50:51], v[38:39] op_sel:[0,0,0] op_sel_hi:[1,0,1]
  s_cbranch_execz L_gt2
  s_waitcnt vmcnt(1)
L_gt2:
  v_dot2_f32_bf16 v48, v64, v12, 0
  v_dot2_f32_bf16 v48, v65, v13, v48
  v_dot2_f32_bf16 v48, v66, v14, v48
  v_dot2_f32_bf16 v48, v67, v15, v48
  s_nop 2
  v_add_f32_dpp v48, v48, v48 row_ror:8 row_mask:0xf bank_mask:0xf
  s_nop 1
  v_add_f32_dpp v48, v48, v48 row_ror:4 row_mask:0xf bank_mask:0xf
  s_nop 1
  v_add_f32_dpp v48, v48, v48 row_ror:2 row_mask:0xf bank_mask:0xf
  s_nop 1
  v_add_f32_dpp v48, v48, v48 row_ror:1 row_mask:0xf bank_mask:0xf
  v_max_f32 v49, v61, v48
  v_sub_f32 v50, v61, v49
  v_sub_f32 v51, v48, v49
  v_mul_f32 v50, s58, v50
  v_mul_f32 v51, s58, v51
  v_exp_f32 v50, v50
  v_exp_f32 v51, v51
  v_mov_b32 v61, v49
  v_fma_f32 v63, v63, v50, v51
  s_cbranch_execz L_gt3
  s_waitcnt vmcnt(0)
L_gt3:
  v_lshlrev_b32 v32, 16, v68
  v_and_b32 v33, s57, v68
  v_lshlrev_b32 v34, 16, v69
  v_and_b32 v35, s57, v69
  v_lshlrev_b32 v36, 16, v70
  v_and_b32 v37, s57, v70
  v_lshlrev_b32 v38, 16, v71
  v_and_b32 v39, s57, v71
  v_pk_mul_f32 v[32:33], v[32:33], v[50:51] op_sel:[0,1] op_sel_hi:[1,1]
  v_pk_mul_f32 v[34:35], v[34:35], v[50:51] op_sel:[0,1] op_sel_hi:[1,1]
  v_pk_mul_f32 v[36:37], v[36:37], v[50:51] op_sel:[0,1] op_sel_hi:[1,1]
  v_pk_mul_f32 v[38:39], v[38:39], v[50:51] op_sel:[0,1] op_sel_hi:[1,1]
  v_pk_fma_f32 v[24:25], v[24:25], v[50:51], v[32:33] op_sel:[0,0,0] op_sel_hi:[1,0,1]
  v_pk_fma_f32 v[26:27], v[26:27], v[50:51], v[34:35] op_sel:[0,0,0] op_sel_hi:[1,0,1]
  v_pk_fma_f32 v[28:29], v[28:29], v[50:51], v[36:37] op_sel:[0,0,0] op_sel_hi:[1,0,1]
  v_pk_fma_f32 v[30:31], v[30:31], v[50:51], v[38:39] op_sel:[0,0,0] op_sel_hi:[1,0,1]
  s_branch L_dyn_done
L_drain1:
  s_cbranch_execz L_gt4
  s_waitcnt vmcnt(3)
L_gt4:
  v_dot2_f32_bf16 v48, v64, v12, 0
  v_dot2_f32_bf16 v48, v65, v13, v48
  v_dot2_f32_bf16 v48, v66, v14, v48
  v_dot2_f32_bf16 v48, v67, v15, v48
  s_nop 2
  v_add_f32_dpp v48, v48, v48 row_ror:8 row_mask:0xf bank_mask:0xf
  s_nop 1
  v_add_f32_dpp v48, v48, v48 row_ror:4 row_mask:0xf bank_mask:0xf
  s_nop 1
  v_add_f32_dpp v48, v48, v48 row_ror:2 row_mask:0xf bank_mask:0xf
  s_nop 1
  v_add_f32_dpp v48, v48, v48 row_ror:1 row_mask:0xf bank_mask:0xf
  v_max_f32 v49, v61, v48
  v_sub_f32 v50, v61, v49
  v_sub_f32 v51, v48, v49
  v_mul_f32 v50, s58, v50
  v_mul_f32 v51, s58, v51
  v_exp_f32 v50, v50
  v_exp_f32 v51, v51
  v_mov_b32 v61, v49
  v_fma_f32 v63, v63, v50, v51
  s_cbranch_execz L_gt5
  s_waitcnt vmcnt(2)
L_gt5:
  v_lshlrev_b32 v32, 16, v68
  v_and_b32 v33, s57, v68
  v_lshlrev_b32 v34, 16, v69
  v_and_b32 v35, s57, v69
  v_lshlrev_b32 v36, 16, v70
  v_and_b32 v37, s57, v70
  v_lshlrev_b32 v38, 16, v71
  v_and_b32 v39, s57, v71
  v_pk_mul_f32 v[32:33], v[32:33], v[50:51] op_sel:[0,1] op_sel_hi:[1,1]
  v_pk_mul_f32 v[34:35], v[34:35], v[50:51] op_sel:[0,1] op_sel_hi:[1,1]
  v_pk_mul_f32 v[36:37], v[36:37], v[50:51] op_sel:[0,1] op_sel_hi:[1,1]
  v_pk_mul_f32 v[38:39], v[38:39], v[50:51] op_sel:[0,1] op_sel_hi:[1,1]
  v_pk_fma_f32 v[24:25], v[24:25], v[50:51], v[32:33] op_sel:[0,0,0] op_sel_hi:[1,0,1]
  v_pk_fma_f32 v[26:27], v[26:27], v[50:51], v[34:35] op_sel:[0,0,0] op_sel_hi:[1,0,1]
  v_pk_fma_f32 v[28:29], v[28:29], v[50:51], v[36:37] op_sel:[0,0,0] op_sel_hi:[1,0,1]
  v_pk_fma_f32 v[30:31], v[30:31], v[50:51], v[38:39] op_sel:[0,0,0] op_sel_hi:[1,0,1]
  s_cbranch_execz L_gt6
  s_waitcnt vmcnt(1)
L_gt6:
  v_dot2_f32_bf16 v48, v72, v12, 0
  v_dot2_f32_bf16 v48, v73, v13, v48
  v_dot2_f32_bf16 v48, v74, v14, v48
  v_dot2_f32_bf16 v48, v75, v15, v48
  s_nop 2
  v_add_f32_dpp v48, v48, v48 row_ror:8 row_mask:0xf bank_mask:0xf
  s_nop 1
  v_add_f32_dpp v48, v48, v48 row_ror:4 row_mask:0xf bank_mask:0xf
  s_nop 1
  v_add_f32_dpp v48, v48, v48 row_ror:2 row_mask:0xf bank_mask:0xf
  s_nop 1
  v_add_f32_dpp v48, v48, v48 row_ror:1 row_mask:0xf bank_mask:0xf
  v_max_f32 v49, v61, v48
  v_sub_f32 v50, v61, v49
  v_sub_f32 v51, v48, v49
  v_mul_f32 v50, s58, v50
  v_mul_f32 v51, s58, v51
  v_exp_f32 v50, v50
  v_exp_f32 v51, v51
  v_mov_b32 v61, v49
  v_fma_f32 v63, v63, v50, v51
  s_cbranch_execz L_gt7
  s_waitcnt vmcnt(0)
L_gt7:
  v_lshlrev_b32 v32, 16, v76
  v_and_b32 v33, s57, v76
  v_lshlrev_b32 v34, 16, v77
  v_and_b32 v35, s57, v77
  v_lshlrev_b32 v36, 16, v78
  v_and_b32 v37, s57, v78
  v_lshlrev_b32 v38, 16, v79
  v_and_b32 v39, s57, v79
  v_pk_mul_f32 v[32:33], v[32:33], v[50:51] op_sel:[0,1] op_sel_hi:[1,1]
  v_pk_mul_f32 v[34:35], v[34:35], v[50:51] op_sel:[0,1] op_sel_hi:[1,1]
  v_pk_mul_f32 v[36:37], v[36:37], v[50:51] op_sel:[0,1] op_sel_hi:[1,1]
  v_pk_mul_f32 v[38:39], v[38:39], v[50:51] op_sel:[0,1] op_sel_hi:[1,1]
  v_pk_fma_f32 v[24:25], v[24:25], v[50:51], v[32:33] op_sel:[0,0,0] op_sel_hi:[1,0,1]
  v_pk_fma_f32 v[26:27], v[26:27], v[50:51], v[34:35] op_sel:[0,0,0] op_sel_hi:[1,0,1]
  v_pk_fma_f32 v[28:29], v[28:29], v[50:51], v[36:37] op_sel:[0,0,0] op_sel_hi:[1,0,1]
  v_pk_fma_f32 v[30:31], v[30:31], v[50:51], v[38:39] op_sel:[0,0,0] op_sel_hi:[1,0,1]
  s_branch L_dyn_done
L_drain2:
  s_cbranch_execz L_gt8
  s_waitcnt vmcnt(3)
L_gt8:
  v_dot2_f32_bf16 v48, v72, v12, 0
  v_dot2_f32_bf16 v48, v73, v13, v48
  v_dot2_f32_bf16 v48, v74, v14, v48
  v_dot2_f32_bf16 v48, v75, v15, v48
  s_nop 2
  v_add_f32_dpp v48, v48, v48 row_ror:8 row_mask:0xf bank_mask:0xf
  s_nop 1
  v_add_f32_dpp v48, v48, v48 row_ror:4 row_mask:0xf bank_mask:0xf
  s_nop 1
  v_add_f32_dpp v48, v48, v48 row_ror:2 row_mask:0xf bank_mask:0xf
  s_nop 1
  v_add_f32_dpp v48, v48, v48 row_ror:1 row_mask:0xf bank_mask:0xf
  v_max_f32 v49, v61, v48
  v_sub_f32 v50, v61, v49
  v_sub_f32 v51, v48, v49
  v_mul_f32 v50, s58, v50
  v_mul_f32 v51, s58, v51
  v_exp_f32 v50, v50
  v_exp_f32 v51, v51
  v_mov_b32 v61, v49
  v_fma_f32 v63, v63, v50, v51
  s_cbranch_execz L_gt9
  s_waitcnt vmcnt(2)
L_gt9:
  v_lshlrev_b32 v32, 16, v76
  v_and_b32 v33, s57, v76
  v_lshlrev_b32 v34, 16, v77
  v_and_b32 v35, s57, v77
  v_lshlrev_b32 v36, 16, v78
  v_and_b32 v37, s57, v78
  v_lshlrev_b32 v38, 16, v79
  v_and_b32 v39, s57, v79
  v_pk_mul_f32 v[32:33], v[32:33], v[50:51] op_sel:[0,1] op_sel_hi:[1,1]
  v_pk_mul_f32 v[34:35], v[34:35], v[50:51] op_sel:[0,1] op_sel_hi:[1,1]
  v_pk_mul_f32 v[36:37], v[36:37], v[50:51] op_sel:[0,1] op_sel_hi:[1,1]
  v_pk_mul_f32 v[38:39], v[38:39], v[50:51] op_sel:[0,1] op_sel_hi:[1,1]
  v_pk_fma_f32 v[24:25], v[24:25], v[50:51], v[32:33] op_sel:[0,0,0] op_sel_hi:[1,0,1]
  v_pk_fma_f32 v[26:27], v[26:27], v[50:51], v[34:35] op_sel:[0,0,0] op_sel_hi:[1,0,1]
  v_pk_fma_f32 v[28:29], v[28:29], v[50:51], v[36:37] op_sel:[0,0,0] op_sel_hi:[1,0,1]
  v_pk_fma_f32 v[30:31], v[30:31], v[50:51], v[38:39] op_sel:[0,0,0] op_sel_hi:[1,0,1]
  s_cbranch_execz L_gt10
  s_waitcnt vmcnt(1)
L_gt10:
  v_dot2_f32_bf16 v48, v160, v12, 0
  v_dot2_f32_bf16 v48, v161, v13, v48
  v_dot2_f32_bf16 v48, v162, v14, v48
  v_dot2_f32_bf16 v48, v163, v15, v48
  s_nop 2
  v_add_f32_dpp v48, v48, v48 row_ror:8 row_mask:0xf bank_mask:0xf
  s_nop 1
  v_add_f32_dpp v48, v48, v48 row_ror:4 row_mask:0xf bank_mask:0xf
  s_nop 1
  v_add_f32_dpp v48, v48, v48 row_ror:2 row_mask:0xf bank_mask:0xf
  s_nop 1
  v_add_f32_dpp v48, v48, v48 row_ror:1 row_mask:0xf bank_mask:0xf
  v_max_f32 v49, v61, v48
  v_sub_f32 v50, v61, v49
  v_sub_f32 v51, v48, v49
  v_mul_f32 v50, s58, v50
  v_mul_f32 v51, s58, v51
  v_exp_f32 v50, v50
  v_exp_f32 v51, v51
  v_mov_b32 v61, v49
  v_fma_f32 v63, v63, v50, v51
  s_cbranch_execz L_gt11
  s_waitcnt vmcnt(0)
L_gt11:
  v_lshlrev_b32 v32, 16, v164
  v_and_b32 v33, s57, v164
  v_lshlrev_b32 v34, 16, v165
  v_and_b32 v35, s57, v165
  v_lshlrev_b32 v36, 16, v166
  v_and_b32 v37, s57, v166
  v_lshlrev_b32 v38, 16, v167
  v_and_b32 v39, s57, v167
  v_pk_mul_f32 v[32:33], v[32:33], v[50:51] op_sel:[0,1] op_sel_hi:[1,1]
  v_pk_mul_f32 v[34:35], v[34:35], v[50:51] op_sel:[0,1] op_sel_hi:[1,1]
  v_pk_mul_f32 v[36:37], v[36:37], v[50:51] op_sel:[0,1] op_sel_hi:[1,1]
  v_pk_mul_f32 v[38:39], v[38:39], v[50:51] op_sel:[0,1] op_sel_hi:[1,1]
  v_pk_fma_f32 v[24:25], v[24:25], v[50:51], v[32:33] op_sel:[0,0,0] op_sel_hi:[1,0,1]
  v_pk_fma_f32 v[26:27], v[26:27], v[50:51], v[34:35] op_sel:[0,0,0] op_sel_hi:[1,0,1]
  v_pk_fma_f32 v[28:29], v[28:29], v[50:51], v[36:37] op_sel:[0,0,0] op_sel_hi:[1,0,1]
  v_pk_fma_f32 v[30:31], v[30:31], v[50:51], v[38:39] op_sel:[0,0,0] op_sel_hi:[1,0,1]
  s_branch L_dyn_done
L_fast:
  s_sub_u32 s60, s88, s68
  s_add_u32 s60, s60, 2
  s_lshr_b32 s60, s60, 2
  s_min_u32 s89, s60, 7
  v_mov_b32 v52, s89
  s_mov_b64 exec, 1
  ds_add_rtn_u32 v52, v7, v52 offset:20
  s_mov_b64 exec, -1
  s_and_b32 s60, s68, 7
  s_lshr_b32 s62, s69, 3
  s_lshl_b32 s62, s62, 3
  s_add_u32 s60, s60, s62
  s_and_b32 s69, s69, 7
  s_lshl_b32 s69, s69, 7
  s_add_u32 s69, s69, s60
  s_lshl_b32 s69, s69, 10
  s_add_u32 s69, s69, s97
  buffer_load_dwordx4 v[80:83], v2, s[40:43], s69 offen nt
  buffer_load_dwordx4 v[84:87], v2, s[44:47], s69 offen nt
  s_waitcnt lgkmcnt(0)
  v_readfirstlane_b32 s68, v52
  s_nop 1
  v_add_u32 v53, s68, v0
  v_lshrrev_b32 v53, 3, v53
  v_min_u32 v53, 127, v53
  v_lshlrev_b32 v53, 2, v53
  ds_read_b32 v55, v53 offset:54528
  s_add_u32 s98, s68, s89
  s_cmp_eq_u32 s89, 0
  s_cselect_b32 s98, s88, s98
  s_sub_i32 s60, s88, s68
  s_max_i32 s60, s60, 0
  s_min_u32 s89, s89, s60
  s_add_u32 s89, s89, 1
  s_waitcnt lgkmcnt(0)
  s_cmp_le_u32 s89, 1
  s_cbranch_scc1 L_fd1
  v_readlane_b32 s69, v55, 0
  s_and_b32 s60, s68, 7
  s_lshr_b32 s62, s69, 3
  s_lshl_b32 s62, s62, 3
  s_add_u32 s60, s60, s62
  s_and_b32 s69, s69, 7
  s_lshl_b32 s69, s69, 7
  s_add_u32 s69, s69, s60
  s_lshl_b32 s69, s69, 10
  s_add_u32 s69, s69, s97
  buffer_load_dwordx4 v[88:91], v2, s[40:43], s69 offen nt
  buffer_load_dwordx4 v[92:95], v2, s[44:47], s69 offen nt
  s_cmp_le_u32 s89, 2
  s_cbranch_scc1 L_fd2
  v_readlane_b32 s69, v55, 1
  s_add_u32 s60, s68, 1
  s_and_b32 s60, s60, 7
  s_lshr_b32 s62, s69, 3
  s_lshl_b32 s62, s62, 3
  s_add_u32 s60, s60, s62
  s_and_b32 s69, s69, 7
  s_lshl_b32 s69, s69, 7
  s_add_u32 s69, s69, s60
  s_lshl_b32 s69, s69, 10
  s_add_u32 s69, s69, s97
  buffer_load_dwordx4 v[96:99], v2, s[40:43], s69 offen nt
  buffer_load_dwordx4 v[100:103], v2, s[44:47], s69 offen nt
  s_cmp_le_u32 s89, 3
  s_cbranch_scc1 L_fd3
  v_readlane_b32 s69, v55, 2
  s_add_u32 s60, s68, 2
  s_and_b32 s60, s60, 7
  s_lshr_b32 s62, s69, 3
  s_lshl_b32 s62, s62, 3
  s_add_u32 s60, s60, s62
  s_and_b32 s69, s69, 7
  s_lshl_b32 s69, s69, 7
  s_add_u32 s69, s69, s60
  s_lshl_b32 s69, s69, 10
  s_add_u32 s69, s69, s97
  buffer_load_dwordx4 v[104:107], v2, s[40:43], s69 offen nt
  buffer_load_dwordx4 v[108:111], v2, s[44:47], s69 offen nt
  s_cmp_le_u32 s89, 4
  s_cbranch_scc1 L_fd4
  v_readlane_b32 s69, v55, 3
  s_add_u32 s60, s68, 3
  s_and_b32 s60, s60, 7
  s_lshr_b32 s62, s69, 3
  s_lshl_b32 s62, s62, 3
  s_add_u32 s60, s60, s62
  s_and_b32 s69, s69, 7
  s_lshl_b32 s69, s69, 7
  s_add_u32 s69, s69, s60
  s_lshl_b32 s69, s69, 10
  s_add_u32 s69, s69, s97
  buffer_load_dwordx4 v[112:115], v2, s[40:43], s69 offen nt
  buffer_load_dwordx4 v[116:119], v2, s[44:47], s69 offen nt
  s_cmp_le_u32 s89, 5
  s_cbranch_scc1 L_fd5
  v_readlane_b32 s69, v55, 4
  s_add_u32 s60, s68, 4
  s_and_b32 s60, s60, 7
  s_lshr_b32 s62, s69, 3
  s_lshl_b32 s62, s62, 3
  s_add_u32 s60, s60, s62
  s_and_b32 s69, s69, 7
  s_lshl_b32 s69, s69, 7
  s_add_u32 s69, s69, s60
  s_lshl_b32 s69, s69, 10
  s_add_u32 s69, s69, s97
  buffer_load_dwordx4 v[120:123], v2, s[40:43], s69 offen nt
  buffer_load_dwordx4 v[124:127], v2, s[44:47], s69 offen nt
  s_cmp_le_u32 s89, 6
  s_cbranch_scc1 L_fd6
  v_readlane_b32 s69, v55, 5
  s_add_u32 s60, s68, 5
  s_and_b32 s60, s60, 7
  s_lshr_b32 s62, s69, 3
  s_lshl_b32 s62, s62, 3
  s_add_u32 s60, s60, s62
  s_and_b32 s69, s69, 7
  s_lshl_b32 s69, s69, 7
  s_add_u32 s69, s69, s60
  s_lshl_b32 s69, s69, 10
  s_add_u32 s69, s69, s97
  buffer_load_dwordx4 v[128:131], v2, s[40:43], s69 offen nt
  buffer_load_dwordx4 v[132:135], v2, s[44:47], s69 offen nt
  s_cmp_le_u32 s89, 7
  s_cbranch_scc1 L_fd7
  v_readlane_b32 s69, v55, 6
  s_add_u32 s60, s68, 6
  s_and_b32 s60, s60, 7
  s_lshr_b32 s62, s69, 3
  s_lshl_b32 s62, s62, 3
  s_add_u32 s60, s60, s62
  s_and_b32 s69, s69, 7
  s_lshl_b32 s69, s69, 7
  s_add_u32 s69, s69, s60
  s_lshl_b32 s69, s69, 10
  s_add_u32 s69, s69, s97
  buffer_load_dwordx4 v[136:139], v2, s[40:43], s69 offen nt
  buffer_load_dwordx4 v[140:143], v2, s[44:47], s69 offen nt
  s_branch L_fi
L_fd1:
  s_mov_b64 exec, 1
  buffer_load_dword v56, v7, s[52:55], 0 offen
  buffer_load_dword v56, v7, s[52:55], 0 offen
L_fd2:
  s_mov_b64 exec, 1
  buffer_load_dword v56, v7, s[52:55], 0 offen
  buffer_load_dword v56, v7, s[52:55], 0 offen
L_fd3:
  s_mov_b64 exec, 1
  buffer_load_dword v56, v7, s[52:55], 0 offen
  buffer_load_dword v56, v7, s[52:55], 0 offen
L_fd4:
  s_mov_b64 exec, 1
  buffer_load_dword v56, v7, s[52:55], 0 offen
  buffer_load_dword v56, v7, s[52:55], 0 offen
L_fd5:
  s_mov_b64 exec, 1
  buffer_load_dword v56, v7, s[52:55], 0 offen
  buffer_load_dword v56, v7, s[52:55], 0 offen
L_fd6:
  s_mov_b64 exec, 1
  buffer_load_dword v56, v7, s[52:55], 0 offen
  buffer_load_dword v56, v7, s[52:55], 0 offen
L_fd7:
  s_mov_b64 exec, 1
  buffer_load_dword v56, v7, s[52:55], 0 offen
  buffer_load_dword v56, v7, s[52:55], 0 offen
  s_mov_b64 exec, -1
L_fi:
  s_cmp_eq_u32 s92, 1
  s_cbranch_scc1 L_fr1
  s_cmp_eq_u32 s92, 2
  s_cbranch_scc1 L_fr2
  s_cmp_eq_u32 s92, 3
  s_cbranch_scc1 L_fc
L_fr0:
  s_waitcnt vmcnt(19)
  v_dot2_f32_bf16 v48, v160, v12, 0
  v_dot2_f32_bf16 v48, v161, v13, v48
  v_dot2_f32_bf16 v48, v162, v14, v48
  v_dot2_f32_bf16 v48, v163, v15, v48
  s_nop 2
  v_add_f32_dpp v48, v48, v48 row_ror:8 row_mask:0xf bank_mask:0xf
  s_nop 1
  v_add_f32_dpp v48, v48, v48 row_ror:4 row_mask:0xf bank_mask:0xf
  s_nop 1
  v_add_f32_dpp v48, v48, v48 row_ror:2 row_mask:0xf bank_mask:0xf
  s_nop 1
  v_add_f32_dpp v48, v48, v48 row_ror:1 row_mask:0xf bank_mask:0xf
  v_max_f32 v49, v61, v48
  v_sub_f32 v50, v61, v49
  v_sub_f32 v51, v48, v49
  v_mul_f32 v50, s58, v50
  v_mul_f32 v51, s58, v51
  v_exp_f32 v50, v50
  v_exp_f32 v51, v51
  v_mov_b32 v61, v49
  v_fma_f32 v63, v63, v50, v51
  s_waitcnt vmcnt(18)
  v_lshlrev_b32 v32, 16, v164
  v_and_b32 v33, s57, v164
  v_lshlrev_b32 v34, 16, v165
  v_and_b32 v35, s57, v165
  v_lshlrev_b32 v36, 16, v166
  v_and_b32 v37, s57, v166
  v_lshlrev_b32 v38, 16, v167
  v_and_b32 v39, s57, v167
  v_pk_mul_f32 v[32:33], v[32:33], v[50:51] op_sel:[0,1] op_sel_hi:[1,1]
  v_pk_mul_f32 v[34:35], v[34:35], v[50:51] op_sel:[0,1] op_sel_hi:[1,1]
  v_pk_mul_f32 v[36:37], v[36:37], v[50:51] op_sel:[0,1] op_sel_hi:[1,1]
  v_pk_mul_f32 v[38:39], v[38:39], v[50:51] op_sel:[0,1] op_sel_hi:[1,1]
  v_pk_fma_f32 v[24:25], v[24:25], v[50:51], v[32:33] op_sel:[0,0,0] op_sel_hi:[1,0,1]
  v_pk_fma_f32 v[26:27], v[26:27], v[50:51], v[34:35] op_sel:[0,0,0] op_sel_hi:[1,0,1]
  v_pk_fma_f32 v[28:29], v[28:29], v[50:51], v[36:37] op_sel:[0,0,0] op_sel_hi:[1,0,1]
  v_pk_fma_f32 v[30:31], v[30:31], v[50:51], v[38:39] op_sel:[0,0,0] op_sel_hi:[1,0,1]
  s_waitcnt vmcnt(17)
  v_dot2_f32_bf16 v48, v64, v12, 0
  v_dot2_f32_bf16 v48, v65, v13, v48
  v_dot2_f32_bf16 v48, v66, v14, v48
  v_dot2_f32_bf16 v48, v67, v15, v48
  s_nop 2
  v_add_f32_dpp v48, v48, v48 row_ror:8 row_mask:0xf bank_mask:0xf
  s_nop 1
  v_add_f32_dpp v48, v48, v48 row_ror:4 row_mask:0xf bank_mask:0xf
  s_nop 1
  v_add_f32_dpp v48, v48, v48 row_ror:2 row_mask:0xf bank_mask:0xf
  s_nop 1
  v_add_f32_dpp v48, v48, v48 row_ror:1 row_mask:0xf bank_mask:0xf
  v_max_f32 v49, v61, v48
  v_sub_f32 v50, v61, v49
  v_sub_f32 v51, v48, v49
  v_mul_f32 v50, s58, v50
  v_mul_f32 v51, s58, v51
  v_exp_f32 v50, v50
  v_exp_f32 v51, v51
  v_mov_b32 v61, v49
  v_fma_f32 v63, v63, v50, v51
  s_waitcnt vmcnt(16)
  v_lshlrev_b32 v32, 16, v68
  v_and_b32 v33, s57, v68
  v_lshlrev_b32 v34, 16, v69
  v_and_b32 v35, s57, v69
  v_lshlrev_b32 v36, 16, v70
  v_and_b32 v37, s57, v70
  v_lshlrev_b32 v38, 16, v71
  v_and_b32 v39, s57, v71
  v_pk_mul_f32 v[32:33], v[32:33], v[50:51] op_sel:[0,1] op_sel_hi:[1,1]
  v_pk_mul_f32 v[34:35], v[34:35], v[50:51] op_sel:[0,1] op_sel_hi:[1,1]
  v_pk_mul_f32 v[36:37], v[36:37], v[50:51] op_sel:[0,1] op_sel_hi:[1,1]
  v_pk_mul_f32 v[38:39], v[38:39], v[50:51] op_sel:[0,1] op_sel_hi:[1,1]
  v_pk_fma_f32 v[24:25], v[24:25], v[50:51], v[32:33] op_sel:[0,0,0] op_sel_hi:[1,0,1]
  v_pk_fma_f32 v[26:27], v[26:27], v[50:51], v[34:35] op_sel:[0,0,0] op_sel_hi:[1,0,1]
  v_pk_fma_f32 v[28:29], v[28:29], v[50:51], v[36:37] op_sel:[0,0,0] op_sel_hi:[1,0,1]
  v_pk_fma_f32 v[30:31], v[30:31], v[50:51], v[38:39] op_sel:[0,0,0] op_sel_hi:[1,0,1]
  s_branch L_fc
L_fr1:
  s_waitcnt vmcnt(19)
  v_dot2_f32_bf16 v48, v64, v12, 0
  v_dot2_f32_bf16 v48, v65, v13, v48
  v_dot2_f32_bf16 v48, v66, v14, v48
  v_dot2_f32_bf16 v48, v67, v15, v48
  s_nop 2
  v_add_f32_dpp v48, v48, v48 row_ror:8 row_mask:0xf bank_mask:0xf
  s_nop 1
  v_add_f32_dpp v48, v48, v48 row_ror:4 row_mask:0xf bank_mask:0xf
  s_nop 1
  v_add_f32_dpp v48, v48, v48 row_ror:2 row_mask:0xf bank_mask:0xf
  s_nop 1
  v_add_f32_dpp v48, v48, v48 row_ror:1 row_mask:0xf bank_mask:0xf
  v_max_f32 v49, v61, v48
  v_sub_f32 v50, v61, v49
  v_sub_f32 v51, v48, v49
  v_mul_f32 v50, s58, v50
  v_mul_f32 v51, s58, v51
  v_exp_f32 v50, v50
  v_exp_f32 v51, v51
  v_mov_b32 v61, v49
  v_fma_f32 v63, v63, v50, v51
  s_waitcnt vmcnt(18)
  v_lshlrev_b32 v32, 16, v68
  v_and_b32 v33, s57, v68
  v_lshlrev_b32 v34, 16, v69
  v_and_b32 v35, s57, v69
  v_lshlrev_b32 v36, 16, v70
  v_and_b32 v37, s57, v70
  v_lshlrev_b32 v38, 16, v71
  v_and_b32 v39, s57, v71
  v_pk_mul_f32 v[32:33], v[32:33], v[50:51] op_sel:[0,1] op_sel_hi:[1,1]
  v_pk_mul_f32 v[34:35], v[34:35], v[50:51] op_sel:[0,1] op_sel_hi:[1,1]
  v_pk_mul_f32 v[36:37], v[36:37], v[50:51] op_sel:[0,1] op_sel_hi:[1,1]
  v_pk_mul_f32 v[38:39], v[38:39], v[50:51] op_sel:[0,1] op_sel_hi:[1,1]
  v_pk_fma_f32 v[24:25], v[24:25], v[50:51], v[32:33] op_sel:[0,0,0] op_sel_hi:[1,0,1]
  v_pk_fma_f32 v[26:27], v[26:27], v[50:51], v[34:35] op_sel:[0,0,0] op_sel_hi:[1,0,1]
  v_pk_fma_f32 v[28:29], v[28:29], v[50:51], v[36:37] op_sel:[0,0,0] op_sel_hi:[1,0,1]
  v_pk_fma_f32 v[30:31], v[30:31], v[50:51], v[38:39] op_sel:[0,0,0] op_sel_hi:[1,0,1]
  s_waitcnt vmcnt(17)
  v_dot2_f32_bf16 v48, v72, v12, 0
  v_dot2_f32_bf16 v48, v73, v13, v48
  v_dot2_f32_bf16 v48, v74, v14, v48
  v_dot2_f32_bf16 v48, v75, v15, v48
  s_nop 2
  v_add_f32_dpp v48, v48, v48 row_ror:8 row_mask:0xf bank_mask:0xf
  s_nop 1
  v_add_f32_dpp v48, v48, v48 row_ror:4 row_mask:0xf bank_mask:0xf
  s_nop 1
  v_add_f32_dpp v48, v48, v48 row_ror:2 row_mask:0xf bank_mask:0xf
  s_nop 1
  v_add_f32_dpp v48, v48, v48 row_ror:1 row_mask:0xf bank_mask:0xf
  v_max_f32 v49, v61, v48
  v_sub_f32 v50, v61, v49
  v_sub_f32 v51, v48, v49
  v_mul_f32 v50, s58, v50
  v_mul_f32 v51, s58, v51
  v_exp_f32 v50, v50
  v_exp_f32 v51, v51
  v_mov_b32 v61, v49
  v_fma_f32 v63, v63, v50, v51
  s_waitcnt vmcnt(16)
  v_lshlrev_b32 v32, 16, v76
  v_and_b32 v33, s57, v76
  v_lshlrev_b32 v34, 16, v77
  v_and_b32 v35, s57, v77
  v_lshlrev_b32 v36, 16, v78
  v_and_b32 v37, s57, v78
  v_lshlrev_b32 v38, 16, v79
  v_and_b32 v39, s57, v79
  v_pk_mul_f32 v[32:33], v[32:33], v[50:51] op_sel:[0,1] op_sel_hi:[1,1]
  v_pk_mul_f32 v[34:35], v[34:35], v[50:51] op_sel:[0,1] op_sel_hi:[1,1]
  v_pk_mul_f32 v[36:37], v[36:37], v[50:51] op_sel:[0,1] op_sel_hi:[1,1]
  v_pk_mul_f32 v[38:39], v[38:39], v[50:51] op_sel:[0,1] op_sel_hi:[1,1]
  v_pk_fma_f32 v[24:25], v[24:25], v[50:51], v[32:33] op_sel:[0,0,0] op_sel_hi:[1,0,1]
  v_pk_fma_f32 v[26:27], v[26:27], v[50:51], v[34:35] op_sel:[0,0,0] op_sel_hi:[1,0,1]
  v_pk_fma_f32 v[28:29], v[28:29], v[50:51], v[36:37] op_sel:[0,0,0] op_sel_hi:[1,0,1]
  v_pk_fma_f32 v[30:31], v[30:31], v[50:51], v[38:39] op_sel:[0,0,0] op_sel_hi:[1,0,1]
  s_branch L_fc
L_fr2:
  s_waitcnt vmcnt(19)
  v_dot2_f32_bf16 v48, v72, v12, 0
  v_dot2_f32_bf16 v48, v73, v13, v48
  v_dot2_f32_bf16 v48, v74, v14, v48
  v_dot2_f32_bf16 v48, v75, v15, v48
  s_nop 2
  v_add_f32_dpp v48, v48, v48 row_ror:8 row_mask:0xf bank_mask:0xf
  s_nop 1
  v_add_f32_dpp v48, v48, v48 row_ror:4 row_mask:0xf bank_mask:0xf
  s_nop 1
  v_add_f32_dpp v48, v48, v48 row_ror:2 row_mask:0xf bank_mask:0xf
  s_nop 1
  v_add_f32_dpp v48, v48, v48 row_ror:1 row_mask:0xf bank_mask:0xf
  v_max_f32 v49, v61, v48
  v_sub_f32 v50, v61, v49
  v_sub_f32 v51, v48, v49
  v_mul_f32 v50, s58, v50
  v_mul_f32 v51, s58, v51
  v_exp_f32 v50, v50
  v_exp_f32 v51, v51
  v_mov_b32 v61, v49
  v_fma_f32 v63, v63, v50, v51
  s_waitcnt vmcnt(18)
  v_lshlrev_b32 v32, 16, v76
  v_and_b32 v33, s57, v76
  v_lshlrev_b32 v34, 16, v77
  v_and_b32 v35, s57, v77
  v_lshlrev_b32 v36, 16, v78
  v_and_b32 v37, s57, v78
  v_lshlrev_b32 v38, 16, v79
  v_and_b32 v39, s57, v79
  v_pk_mul_f32 v[32:33], v[32:33], v[50:51] op_sel:[0,1] op_sel_hi:[1,1]
  v_pk_mul_f32 v[34:35], v[34:35], v[50:51] op_sel:[0,1] op_sel_hi:[1,1]
  v_pk_mul_f32 v[36:37], v[36:37], v[50:51] op_sel:[0,1] op_sel_hi:[1,1]
  v_pk_mul_f32 v[38:39], v[38:39], v[50:51] op_sel:[0,1] op_sel_hi:[1,1]
  v_pk_fma_f32 v[24:25], v[24:25], v[50:51], v[32:33] op_sel:[0,0,0] op_sel_hi:[1,0,1]
  v_pk_fma_f32 v[26:27], v[26:27], v[50:51], v[34:35] op_sel:[0,0,0] op_sel_hi:[1,0,1]
  v_pk_fma_f32 v[28:29], v[28:29], v[50:51], v[36:37] op_sel:[0,0,0] op_sel_hi:[1,0,1]
  v_pk_fma_f32 v[30:31], v[30:31], v[50:51], v[38:39] op_sel:[0,0,0] op_sel_hi:[1,0,1]
  s_waitcnt vmcnt(17)
  v_dot2_f32_bf16 v48, v160, v12, 0
  v_dot2_f32_bf16 v48, v161, v13, v48
  v_dot2_f32_bf16 v48, v162, v14, v48
  v_dot2_f32_bf16 v48, v163, v15, v48
  s_nop 2
  v_add_f32_dpp v48, v48, v48 row_ror:8 row_mask:0xf bank_mask:0xf
  s_nop 1
  v_add_f32_dpp v48, v48, v48 row_ror:4 row_mask:0xf bank_mask:0xf
  s_nop 1
  v_add_f32_dpp v48, v48, v48 row_ror:2 row_mask:0xf bank_mask:0xf
  s_nop 1
  v_add_f32_dpp v48, v48, v48 row_ror:1 row_mask:0xf bank_mask:0xf
  v_max_f32 v49, v61, v48
  v_sub_f32 v50, v61, v49
  v_sub_f32 v51, v48, v49
  v_mul_f32 v50, s58, v50
  v_mul_f32 v51, s58, v51
  v_exp_f32 v50, v50
  v_exp_f32 v51, v51
  v_mov_b32 v61, v49
  v_fma_f32 v63, v63, v50, v51
  s_waitcnt vmcnt(16)
  v_lshlrev_b32 v32, 16, v164
  v_and_b32 v33, s57, v164
  v_lshlrev_b32 v34, 16, v165
  v_and_b32 v35, s57, v165
  v_lshlrev_b32 v36, 16, v166
  v_and_b32 v37, s57, v166
  v_lshlrev_b32 v38, 16, v167
  v_and_b32 v39, s57, v167
  v_pk_mul_f32 v[32:33], v[32:33], v[50:51] op_sel:[0,1] op_sel_hi:[1,1]
  v_pk_mul_f32 v[34:35], v[34:35], v[50:51] op_sel:[0,1] op_sel_hi:[1,1]
  v_pk_mul_f32 v[36:37], v[36:37], v[50:51] op_sel:[0,1] op_sel_hi:[1,1]
  v_pk_mul_f32 v[38:39], v[38:39], v[50:51] op_sel:[0,1] op_sel_hi:[1,1]
  v_pk_fma_f32 v[24:25], v[24:25], v[50:51], v[32:33] op_sel:[0,0,0] op_sel_hi:[1,0,1]
  v_pk_fma_f32 v[26:27], v[26:27], v[50:51], v[34:35] op_sel:[0,0,0] op_sel_hi:[1,0,1]
  v_pk_fma_f32 v[28:29], v[28:29], v[50:51], v[36:37] op_sel:[0,0,0] op_sel_hi:[1,0,1]
  v_pk_fma_f32 v[30:31], v[30:31], v[50:51], v[38:39] op_sel:[0,0,0] op_sel_hi:[1,0,1]
L_fc:
  s_waitcnt vmcnt(15)
  v_dot2_f32_bf16 v48, v80, v12, 0
  v_dot2_f32_bf16 v48, v81, v13, v48
  v_dot2_f32_bf16 v48, v82, v14, v48
  v_dot2_f32_bf16 v48, v83, v15, v48
  s_nop 2
  v_add_f32_dpp v48, v48, v48 row_ror:8 row_mask:0xf bank_mask:0xf
  s_nop 1
  v_add_f32_dpp v48, v48, v48 row_ror:4 row_mask:0xf bank_mask:0xf
  s_nop 1
  v_add_f32_dpp v48, v48, v48 row_ror:2 row_mask:0xf bank_mask:0xf
  s_nop 1
  v_add_f32_dpp v48, v48, v48 row_ror:1 row_mask:0xf bank_mask:0xf
  v_max_f32 v49, v61, v48
  v_sub_f32 v50, v61, v49
  v_sub_f32 v51, v48, v49
  v_mul_f32 v50, s58, v50
  v_mul_f32 v51, s58, v51
  v_exp_f32 v50, v50
  v_exp_f32 v51, v51
  v_mov_b32 v61, v49
  v_fma_f32 v63, v63, v50, v51
  s_waitcnt vmcnt(14)
  v_lshlrev_b32 v32, 16, v84
  v_and_b32 v33, s57, v84
  v_lshlrev_b32 v34, 16, v85
  v_and_b32 v35, s57, v85
  v_lshlrev_b32 v36, 16, v86
  v_and_b32 v37, s57, v86
  v_lshlrev_b32 v38, 16, v87
  v_and_b32 v39, s57, v87
  v_pk_mul_f32 v[32:33], v[32:33], v[50:51] op_sel:[0,1] op_sel_hi:[1,1]
  v_pk_mul_f32 v[34:35], v[34:35], v[50:51] op_sel:[0,1] op_sel_hi:[1,1]
  v_pk_mul_f32 v[36:37], v[36:37], v[50:51] op_sel:[0,1] op_sel_hi:[1,1]
  v_pk_mul_f32 v[38:39], v[38:39], v[50:51] op_sel:[0,1] op_sel_hi:[1,1]
  v_pk_fma_f32 v[24:25], v[24:25], v[50:51], v[32:33] op_sel:[0,0,0] op_sel_hi:[1,0,1]
  v_pk_fma_f32 v[26:27], v[26:27], v[50:51], v[34:35] op_sel:[0,0,0] op_sel_hi:[1,0,1]
  v_pk_fma_f32 v[28:29], v[28:29], v[50:51], v[36:37] op_sel:[0,0,0] op_sel_hi:[1,0,1]
  v_pk_fma_f32 v[30:31], v[30:31], v[50:51], v[38:39] op_sel:[0,0,0] op_sel_hi:[1,0,1]
  s_cmp_le_u32 s89, 1
  s_cbranch_scc1 L_refill
  s_waitcnt vmcnt(13)
  v_dot2_f32_bf16 v48, v88, v12, 0
  v_dot2_f32_bf16 v48, v89, v13, v48
  v_dot2_f32_bf16 v48, v90, v14, v48
  v_dot2_f32_bf16 v48, v91, v15, v48
  s_nop 2
  v_add_f32_dpp v48, v48, v48 row_ror:8 row_mask:0xf bank_mask:0xf
  s_nop 1
  v_add_f32_dpp v48, v48, v48 row_ror:4 row_mask:0xf bank_mask:0xf
  s_nop 1
  v_add_f32_dpp v48, v48, v48 row_ror:2 row_mask:0xf bank_mask:0xf
  s_nop 1
  v_add_f32_dpp v48, v48, v48 row_ror:1 row_mask:0xf bank_mask:0xf
  v_max_f32 v49, v61, v48
  v_sub_f32 v50, v61, v49
  v_sub_f32 v51, v48, v49
  v_mul_f32 v50, s58, v50
  v_mul_f32 v51, s58, v51
  v_exp_f32 v50, v50
  v_exp_f32 v51, v51
  v_mov_b32 v61, v49
  v_fma_f32 v63, v63, v50, v51
  s_waitcnt vmcnt(12)
  v_lshlrev_b32 v32, 16, v92
  v_and_b32 v33, s57, v92
  v_lshlrev_b32 v34, 16, v93
  v_and_b32 v35, s57, v93
  v_lshlrev_b32 v36, 16, v94
  v_and_b32 v37, s57, v94
  v_lshlrev_b32 v38, 16, v95
  v_and_b32 v39, s57, v95
  v_pk_mul_f32 v[32:33], v[32:33], v[50:51] op_sel:[0,1] op_sel_hi:[1,1]
  v_pk_mul_f32 v[34:35], v[34:35], v[50:51] op_sel:[0,1] op_sel_hi:[1,1]
  v_pk_mul_f32 v[36:37], v[36:37], v[50:51] op_sel:[0,1] op_sel_hi:[1,1]
  v_pk_mul_f32 v[38:39], v[38:39], v[50:51] op_sel:[0,1] op_sel_hi:[1,1]
  v_pk_fma_f32 v[24:25], v[24:25], v[50:51], v[32:33] op_sel:[0,0,0] op_sel_hi:[1,0,1]
  v_pk_fma_f32 v[26:27], v[26:27], v[50:51], v[34:35] op_sel:[0,0,0] op_sel_hi:[1,0,1]
  v_pk_fma_f32 v[28:29], v[28:29], v[50:51], v[36:37] op_sel:[0,0,0] op_sel_hi:[1,0,1]
  v_pk_fma_f32 v[30:31], v[30:31], v[50:51], v[38:39] op_sel:[0,0,0] op_sel_hi:[1,0,1]
  s_cmp_le_u32 s89, 2
  s_cbranch_scc1 L_refill
  s_waitcnt vmcnt(11)
  v_dot2_f32_bf16 v48, v96, v12, 0
  v_dot2_f32_bf16 v48, v97, v13, v48
  v_dot2_f32_bf16 v48, v98, v14, v48
  v_dot2_f32_bf16 v48, v99, v15, v48
  s_nop 2
  v_add_f32_dpp v48, v48, v48 row_ror:8 row_mask:0xf bank_mask:0xf
  s_nop 1
  v_add_f32_dpp v48, v48, v48 row_ror:4 row_mask:0xf bank_mask:0xf
  s_nop 1
  v_add_f32_dpp v48, v48, v48 row_ror:2 row_mask:0xf bank_mask:0xf
  s_nop 1
  v_add_f32_dpp v48, v48, v48 row_ror:1 row_mask:0xf bank_mask:0xf
  v_max_f32 v49, v61, v48
  v_sub_f32 v50, v61, v49
  v_sub_f32 v51, v48, v49
  v_mul_f32 v50, s58, v50
  v_mul_f32 v51, s58, v51
  v_exp_f32 v50, v50
  v_exp_f32 v51, v51
  v_mov_b32 v61, v49
  v_fma_f32 v63, v63, v50, v51
  s_waitcnt vmcnt(10)
  v_lshlrev_b32 v32, 16, v100
  v_and_b32 v33, s57, v100
  v_lshlrev_b32 v34, 16, v101
  v_and_b32 v35, s57, v101
  v_lshlrev_b32 v36, 16, v102
  v_and_b32 v37, s57, v102
  v_lshlrev_b32 v38, 16, v103
  v_and_b32 v39, s57, v103
  v_pk_mul_f32 v[32:33], v[32:33], v[50:51] op_sel:[0,1] op_sel_hi:[1,1]
  v_pk_mul_f32 v[34:35], v[34:35], v[50:51] op_sel:[0,1] op_sel_hi:[1,1]
  v_pk_mul_f32 v[36:37], v[36:37], v[50:51] op_sel:[0,1] op_sel_hi:[1,1]
  v_pk_mul_f32 v[38:39], v[38:39], v[50:51] op_sel:[0,1] op_sel_hi:[1,1]
  v_pk_fma_f32 v[24:25], v[24:25], v[50:51], v[32:33] op_sel:[0,0,0] op_sel_hi:[1,0,1]
  v_pk_fma_f32 v[26:27], v[26:27], v[50:51], v[34:35] op_sel:[0,0,0] op_sel_hi:[1,0,1]
  v_pk_fma_f32 v[28:29], v[28:29], v[50:51], v[36:37] op_sel:[0,0,0] op_sel_hi:[1,0,1]
  v_pk_fma_f32 v[30:31], v[30:31], v[50:51], v[38:39] op_sel:[0,0,0] op_sel_hi:[1,0,1]
  s_cmp_le_u32 s89, 3
  s_cbranch_scc1 L_refill
  s_waitcnt vmcnt(9)
  v_dot2_f32_bf16 v48, v104, v12, 0
  v_dot2_f32_bf16 v48, v105, v13, v48
  v_dot2_f32_bf16 v48, v106, v14, v48
  v_dot2_f32_bf16 v48, v107, v15, v48
  s_nop 2
  v_add_f32_dpp v48, v48, v48 row_ror:8 row_mask:0xf bank_mask:0xf
  s_nop 1
  v_add_f32_dpp v48, v48, v48 row_ror:4 row_mask:0xf bank_mask:0xf
  s_nop 1
  v_add_f32_dpp v48, v48, v48 row_ror:2 row_mask:0xf bank_mask:0xf
  s_nop 1
  v_add_f32_dpp v48, v48, v48 row_ror:1 row_mask:0xf bank_mask:0xf
  v_max_f32 v49, v61, v48
  v_sub_f32 v50, v61, v49
  v_sub_f32 v51, v48, v49
  v_mul_f32 v50, s58, v50
  v_mul_f32 v51, s58, v51
  v_exp_f32 v50, v50
  v_exp_f32 v51, v51
  v_mov_b32 v61, v49
  v_fma_f32 v63, v63, v50, v51
  s_waitcnt vmcnt(8)
  v_lshlrev_b32 v32, 16, v108
  v_and_b32 v33, s57, v108
  v_lshlrev_b32 v34, 16, v109
  v_and_b32 v35, s57, v109
  v_lshlrev_b32 v36, 16, v110
  v_and_b32 v37, s57, v110
  v_lshlrev_b32 v38, 16, v111
  v_and_b32 v39, s57, v111
  v_pk_mul_f32 v[32:33], v[32:33], v[50:51] op_sel:[0,1] op_sel_hi:[1,1]
  v_pk_mul_f32 v[34:35], v[34:35], v[50:51] op_sel:[0,1] op_sel_hi:[1,1]
  v_pk_mul_f32 v[36:37], v[36:37], v[50:51] op_sel:[0,1] op_sel_hi:[1,1]
  v_pk_mul_f32 v[38:39], v[38:39], v[50:51] op_sel:[0,1] op_sel_hi:[1,1]
  v_pk_fma_f32 v[24:25], v[24:25], v[50:51], v[32:33] op_sel:[0,0,0] op_sel_hi:[1,0,1]
  v_pk_fma_f32 v[26:27], v[26:27], v[50:51], v[34:35] op_sel:[0,0,0] op_sel_hi:[1,0,1]
  v_pk_fma_f32 v[28:29], v[28:29], v[50:51], v[36:37] op_sel:[0,0,0] op_sel_hi:[1,0,1]
  v_pk_fma_f32 v[30:31], v[30:31], v[50:51], v[38:39] op_sel:[0,0,0] op_sel_hi:[1,0,1]
  s_cmp_le_u32 s89, 4
  s_cbranch_scc1 L_refill
  s_waitcnt vmcnt(7)
  v_dot2_f32_bf16 v48, v112, v12, 0
  v_dot2_f32_bf16 v48, v113, v13, v48
  v_dot2_f32_bf16 v48, v114, v14, v48
  v_dot2_f32_bf16 v48, v115, v15, v48
  s_nop 2
  v_add_f32_dpp v48, v48, v48 row_ror:8 row_mask:0xf bank_mask:0xf
  s_nop 1
  v_add_f32_dpp v48, v48, v48 row_ror:4 row_mask:0xf bank_mask:0xf
  s_nop 1
  v_add_f32_dpp v48, v48, v48 row_ror:2 row_mask:0xf bank_mask:0xf
  s_nop 1
  v_add_f32_dpp v48, v48, v48 row_ror:1 row_mask:0xf bank_mask:0xf
  v_max_f32 v49, v61, v48
  v_sub_f32 v50, v61, v49
  v_sub_f32 v51, v48, v49
  v_mul_f32 v50, s58, v50
  v_mul_f32 v51, s58, v51
  v_exp_f32 v50, v50
  v_exp_f32 v51, v51
  v_mov_b32 v61, v49
  v_fma_f32 v63, v63, v50, v51
  s_waitcnt vmcnt(6)
  v_lshlrev_b32 v32, 16, v116
  v_and_b32 v33, s57, v116
  v_lshlrev_b32 v34, 16, v117
  v_and_b32 v35, s57, v117
  v_lshlrev_b32 v36, 16, v118
  v_and_b32 v37, s57, v118
  v_lshlrev_b32 v38, 16, v119
  v_and_b32 v39, s57, v119
  v_pk_mul_f32 v[32:33], v[32:33], v[50:51] op_sel:[0,1] op_sel_hi:[1,1]
  v_pk_mul_f32 v[34:35], v[34:35], v[50:51] op_sel:[0,1] op_sel_hi:[1,1]
  v_pk_mul_f32 v[36:37], v[36:37], v[50:51] op_sel:[0,1] op_sel_hi:[1,1]
  v_pk_mul_f32 v[38:39], v[38:39], v[50:51] op_sel:[0,1] op_sel_hi:[1,1]
  v_pk_fma_f32 v[24:25], v[24:25], v[50:51], v[32:33] op_sel:[0,0,0] op_sel_hi:[1,0,1]
  v_pk_fma_f32 v[26:27], v[26:27], v[50:51], v[34:35] op_sel:[0,0,0] op_sel_hi:[1,0,1]
  v_pk_fma_f32 v[28:29], v[28:29], v[50:51], v[36:37] op_sel:[0,0,0] op_sel_hi:[1,0,1]
  v_pk_fma_f32 v[30:31], v[30:31], v[50:51], v[38:39] op_sel:[0,0,0] op_sel_hi:[1,0,1]
  s_cmp_le_u32 s89, 5
  s_cbranch_scc1 L_refill
  s_waitcnt vmcnt(5)
  v_dot2_f32_bf16 v48, v120, v12, 0
  v_dot2_f32_bf16 v48, v121, v13, v48
  v_dot2_f32_bf16 v48, v122, v14, v48
  v_dot2_f32_bf16 v48, v123, v15, v48
  s_nop 2
  v_add_f32_dpp v48, v48, v48 row_ror:8 row_mask:0xf bank_mask:0xf
  s_nop 1
  v_add_f32_dpp v48, v48, v48 row_ror:4 row_mask:0xf bank_mask:0xf
  s_nop 1
  v_add_f32_dpp v48, v48, v48 row_ror:2 row_mask:0xf bank_mask:0xf
  s_nop 1
  v_add_f32_dpp v48, v48, v48 row_ror:1 row_mask:0xf bank_mask:0xf
  v_max_f32 v49, v61, v48
  v_sub_f32 v50, v61, v49
  v_sub_f32 v51, v48, v49
  v_mul_f32 v50, s58, v50
  v_mul_f32 v51, s58, v51
  v_exp_f32 v50, v50
  v_exp_f32 v51, v51
  v_mov_b32 v61, v49
  v_fma_f32 v63, v63, v50, v51
  s_waitcnt vmcnt(4)
  v_lshlrev_b32 v32, 16, v124
  v_and_b32 v33, s57, v124
  v_lshlrev_b32 v34, 16, v125
  v_and_b32 v35, s57, v125
  v_lshlrev_b32 v36, 16, v126
  v_and_b32 v37, s57, v126
  v_lshlrev_b32 v38, 16, v127
  v_and_b32 v39, s57, v127
  v_pk_mul_f32 v[32:33], v[32:33], v[50:51] op_sel:[0,1] op_sel_hi:[1,1]
  v_pk_mul_f32 v[34:35], v[34:35], v[50:51] op_sel:[0,1] op_sel_hi:[1,1]
  v_pk_mul_f32 v[36:37], v[36:37], v[50:51] op_sel:[0,1] op_sel_hi:[1,1]
  v_pk_mul_f32 v[38:39], v[38:39], v[50:51] op_sel:[0,1] op_sel_hi:[1,1]
  v_pk_fma_f32 v[24:25], v[24:25], v[50:51], v[32:33] op_sel:[0,0,0] op_sel_hi:[1,0,1]
  v_pk_fma_f32 v[26:27], v[26:27], v[50:51], v[34:35] op_sel:[0,0,0] op_sel_hi:[1,0,1]
  v_pk_fma_f32 v[28:29], v[28:29], v[50:51], v[36:37] op_sel:[0,0,0] op_sel_hi:[1,0,1]
  v_pk_fma_f32 v[30:31], v[30:31], v[50:51], v[38:39] op_sel:[0,0,0] op_sel_hi:[1,0,1]
  s_cmp_le_u32 s89, 6
  s_cbranch_scc1 L_refill
  s_waitcnt vmcnt(3)
  v_dot2_f32_bf16 v48, v128, v12, 0
  v_dot2_f32_bf16 v48, v129, v13, v48
  v_dot2_f32_bf16 v48, v130, v14, v48
  v_dot2_f32_bf16 v48, v131, v15, v48
  s_nop 2
  v_add_f32_dpp v48, v48, v48 row_ror:8 row_mask:0xf bank_mask:0xf
  s_nop 1
  v_add_f32_dpp v48, v48, v48 row_ror:4 row_mask:0xf bank_mask:0xf
  s_nop 1
  v_add_f32_dpp v48, v48, v48 row_ror:2 row_mask:0xf bank_mask:0xf
  s_nop 1
  v_add_f32_dpp v48, v48, v48 row_ror:1 row_mask:0xf bank_mask:0xf
  v_max_f32 v49, v61, v48
  v_sub_f32 v50, v61, v49
  v_sub_f32 v51, v48, v49
  v_mul_f32 v50, s58, v50
  v_mul_f32 v51, s58, v51
  v_exp_f32 v50, v50
  v_exp_f32 v51, v51
  v_mov_b32 v61, v49
  v_fma_f32 v63, v63, v50, v51
  s_waitcnt vmcnt(2)
  v_lshlrev_b32 v32, 16, v132
  v_and_b32 v33, s57, v132
  v_lshlrev_b32 v34, 16, v133
  v_and_b32 v35, s57, v133
  v_lshlrev_b32 v36, 16, v134
  v_and_b32 v37, s57, v134
  v_lshlrev_b32 v38, 16, v135
  v_and_b32 v39, s57, v135
  v_pk_mul_f32 v[32:33], v[32:33], v[50:51] op_sel:[0,1] op_sel_hi:[1,1]
  v_pk_mul_f32 v[34:35], v[34:35], v[50:51] op_sel:[0,1] op_sel_hi:[1,1]
  v_pk_mul_f32 v[36:37], v[36:37], v[50:51] op_sel:[0,1] op_sel_hi:[1,1]
  v_pk_mul_f32 v[38:39], v[38:39], v[50:51] op_sel:[0,1] op_sel_hi:[1,1]
  v_pk_fma_f32 v[24:25], v[24:25], v[50:51], v[32:33] op_sel:[0,0,0] op_sel_hi:[1,0,1]
  v_pk_fma_f32 v[26:27], v[26:27], v[50:51], v[34:35] op_sel:[0,0,0] op_sel_hi:[1,0,1]
  v_pk_fma_f32 v[28:29], v[28:29], v[50:51], v[36:37] op_sel:[0,0,0] op_sel_hi:[1,0,1]
  v_pk_fma_f32 v[30:31], v[30:31], v[50:51], v[38:39] op_sel:[0,0,0] op_sel_hi:[1,0,1]
  s_cmp_le_u32 s89, 7
  s_cbranch_scc1 L_refill
  s_waitcnt vmcnt(1)
  v_dot2_f32_bf16 v48, v136, v12, 0
  v_dot2_f32_bf16 v48, v137, v13, v48
  v_dot2_f32_bf16 v48, v138, v14, v48
  v_dot2_f32_bf16 v48, v139, v15, v48
  s_nop 2
  v_add_f32_dpp v48, v48, v48 row_ror:8 row_mask:0xf bank_mask:0xf
  s_nop 1
  v_add_f32_dpp v48, v48, v48 row_ror:4 row_mask:0xf bank_mask:0xf
  s_nop 1
  v_add_f32_dpp v48, v48, v48 row_ror:2 row_mask:0xf bank_mask:0xf
  s_nop 1
  v_add_f32_dpp v48, v48, v48 row_ror:1 row_mask:0xf bank_mask:0xf
  v_max_f32 v49, v61, v48
  v_sub_f32 v50, v61, v49
  v_sub_f32 v51, v48, v49
  v_mul_f32 v50, s58, v50
  v_mul_f32 v51, s58, v51
  v_exp_f32 v50, v50
  v_exp_f32 v51, v51
  v_mov_b32 v61, v49
  v_fma_f32 v63, v63, v50, v51
  s_waitcnt vmcnt(0)
  v_lshlrev_b32 v32, 16, v140
  v_and_b32 v33, s57, v140
  v_lshlrev_b32 v34, 16, v141
  v_and_b32 v35, s57, v141
  v_lshlrev_b32 v36, 16, v142
  v_and_b32 v37, s57, v142
  v_lshlrev_b32 v38, 16, v143
  v_and_b32 v39, s57, v143
  v_pk_mul_f32 v[32:33], v[32:33], v[50:51] op_sel:[0,1] op_sel_hi:[1,1]
  v_pk_mul_f32 v[34:35], v[34:35], v[50:51] op_sel:[0,1] op_sel_hi:[1,1]
  v_pk_mul_f32 v[36:37], v[36:37], v[50:51] op_sel:[0,1] op_sel_hi:[1,1]
  v_pk_mul_f32 v[38:39], v[38:39], v[50:51] op_sel:[0,1] op_sel_hi:[1,1]
  v_pk_fma_f32 v[24:25], v[24:25], v[50:51], v[32:33] op_sel:[0,0,0] op_sel_hi:[1,0,1]
  v_pk_fma_f32 v[26:27], v[26:27], v[50:51], v[34:35] op_sel:[0,0,0] op_sel_hi:[1,0,1]
  v_pk_fma_f32 v[28:29], v[28:29], v[50:51], v[36:37] op_sel:[0,0,0] op_sel_hi:[1,0,1]
  v_pk_fma_f32 v[30:31], v[30:31], v[50:51], v[38:39] op_sel:[0,0,0] op_sel_hi:[1,0,1]
L_refill:
  s_cmp_ge_u32 s98, s88
  s_cbranch_scc1 L_dyn_done
  s_mov_b64 exec, 1
  ds_add_rtn_u32 v52, v7, v58 offset:20
  s_mov_b64 exec, -1
  s_waitcnt lgkmcnt(0)
  v_readfirstlane_b32 s68, v52
  s_nop 0
  s_cmp_ge_u32 s68, s88
  s_cbranch_scc1 L_dyn_done
  s_lshr_b32 s60, s68, 3
  s_min_u32 s60, s60, 127
  s_lshl_b32 s60, s60, 2
  v_mov_b32 v53, s60
  ds_read_b32 v55, v53 offset:54528
  s_waitcnt lgkmcnt(0)
  v_readfirstlane_b32 s69, v55
  s_mov_b32 s92, 3
  s_branch L_fast
L_dyn_done:
  v_mov_b32 v48, v61
  v_mov_b32 v32, v61
  s_nop 1
  v_permlane32_swap_b32 v61, v32
  v_max_f32 v61, v61, v32
  v_mov_b32 v32, v61
  s_nop 1
  v_permlane16_swap_b32 v61, v32
  v_max_f32 v61, v61, v32
  v_sub_f32 v48, v48, v61
  v_mul_f32 v48, s58, v48
  v_exp_f32 v48, v48
  s_nop 0
  v_mul_f32 v63, v63, v48
  v_pk_mul_f32 v[24:25], v[24:25], v[48:49] op_sel:[0,0] op_sel_hi:[1,0]
  v_pk_mul_f32 v[26:27], v[26:27], v[48:49] op_sel:[0,0] op_sel_hi:[1,0]
  v_pk_mul_f32 v[28:29], v[28:29], v[48:49] op_sel:[0,0] op_sel_hi:[1,0]
  v_pk_mul_f32 v[30:31], v[30:31], v[48:49] op_sel:[0,0] op_sel_hi:[1,0]
  v_mov_b32 v32, v63
  s_nop 1
  v_permlane32_swap_b32 v63, v32
  v_add_f32 v63, v63, v32
  v_mov_b32 v32, v63
  s_nop 1
  v_permlane16_swap_b32 v63, v32
  v_add_f32 v63, v63, v32
  v_permlane32_swap_b32 v16, v20
  v_permlane32_swap_b32 v17, v21
  v_permlane32_swap_b32 v18, v22
  v_permlane32_swap_b32 v19, v23
  v_add_f32 v16, v16, v20
  v_add_f32 v17, v17, v21
  v_add_f32 v18, v18, v22
  v_add_f32 v19, v19, v23
  s_nop 0
  v_permlane16_swap_b32 v16, v18
  v_permlane16_swap_b32 v17, v19
  v_add_f32 v16, v16, v18
  v_add_f32 v17, v17, v19
  v_permlane32_swap_b32 v24, v28
  v_permlane32_swap_b32 v25, v29
  v_permlane32_swap_b32 v26, v30
  v_permlane32_swap_b32 v27, v31
  v_add_f32 v24, v24, v28
  v_add_f32 v25, v25, v29
  v_add_f32 v26, v26, v30
  v_add_f32 v27, v27, v31
  s_nop 0
  v_permlane16_swap_b32 v24, v26
  v_permlane16_swap_b32 v25, v27
  v_add_f32 v24, v24, v26
  v_add_f32 v25, v25, v27
  v_mov_b32 v34, v61
  v_mov_b32 v35, v63
  s_lshl_b32 s60, s3, 4
  v_mov_b32 v36, s60
  s_and_b64 exec, s[90:91], 1
  ds_write_b64 v36, v[34:35] offset:72
  s_and_b64 exec, s[90:91], -1
  s_lshl_b32 s60, s3, 10
  v_add_u32 v1, s60, v5
  ds_write_b64 v1, v[16:17] offset:5376
  ds_write_b64 v1, v[24:25] offset:5888
  s_waitcnt lgkmcnt(0)
  v_mov_b32 v1, 1
  s_mov_b64 exec, 1
  ds_add_u32 v7, v1 offset:28
  s_mov_b64 exec, -1
  s_cmp_lt_u32 s31, 4
  s_cselect_b32 s48, s12, s22
  s_cselect_b32 s49, s13, s23
  v_lshrrev_b32 v1, 3, v0
  v_and_b32 v3, 7, v0
  v_lshlrev_b32 v3, 4, v3
  s_cmp_ge_u32 s3, 4
  s_cbranch_scc1 L_wolh
  v_mul_u32_u24 v1, 10240, v1
  v_add_u32 v1, v1, v3
  s_lshl_b32 s60, s30, 7
  s_and_b32 s62, s3, 1
  s_lshl_b32 s62, s62, 6
  s_add_u32 s60, s60, s62
  s_mul_i32 s60, s60, 1280
  s_lshr_b32 s62, s3, 1
  s_add_u32 s62, s62, s101
  s_lshl_b32 s62, s62, 7
  s_add_u32 s60, s60, s62
  s_add_u32 s62, s60, 0
  buffer_load_dwordx4 v[64:67], v1, s[48:51], s62 offen nt
  s_add_u32 s62, s60, 1280
  buffer_load_dwordx4 v[68:71], v1, s[48:51], s62 offen nt
  s_add_u32 s62, s60, 2560
  buffer_load_dwordx4 v[72:75], v1, s[48:51], s62 offen nt
  s_add_u32 s62, s60, 3840
  buffer_load_dwordx4 v[76:79], v1, s[48:51], s62 offen nt
  s_add_u32 s62, s60, 5120
  buffer_load_dwordx4 v[80:83], v1, s[48:51], s62 offen nt
  s_add_u32 s62, s60, 6400
  buffer_load_dwordx4 v[84:87], v1, s[48:51], s62 offen nt
  s_add_u32 s62, s60, 7680
  buffer_load_dwordx4 v[88:91], v1, s[48:51], s62 offen nt
  s_add_u32 s62, s60, 8960
  buffer_load_dwordx4 v[92:95], v1, s[48:51], s62 offen nt
  s_branch L_nowol
L_wolh:
  s_cmp_eq_u32 s100, 4
  s_cbranch_scc1 L_nowol
  v_mul_u32_u24 v1, 5120, v1
  v_add_u32 v1, v1, v3
  s_lshl_b32 s60, s30, 7
  s_sub_u32 s62, s3, 4
  s_lshl_b32 s62, s62, 5
  s_add_u32 s60, s60, s62
  s_mul_i32 s60, s60, 1280
  s_add_u32 s62, s101, 2
  s_lshl_b32 s62, s62, 7
  s_add_u32 s60, s60, s62
  s_add_u32 s62, s60, 0
  buffer_load_dwordx4 v[64:67], v1, s[48:51], s62 offen nt
  s_add_u32 s62, s60, 1280
  buffer_load_dwordx4 v[68:71], v1, s[48:51], s62 offen nt
  s_add_u32 s62, s60, 2560
  buffer_load_dwordx4 v[72:75], v1, s[48:51], s62 offen nt
  s_add_u32 s62, s60, 3840
  buffer_load_dwordx4 v[76:79], v1, s[48:51], s62 offen nt
L_nowol:
  s_cmp_ge_u32 s3, 4
  s_cbranch_scc1 L_half
  v_lshrrev_b32 v3, 3, v0
  v_lshlrev_b32 v3, 5, v3
  s_and_b32 s62, s3, 1
  s_lshl_b32 s62, s62, 8
  v_add_u32 v3, s62, v3
  s_lshr_b32 s60, s31, 2
  s_mul_i32 s60, s60, 80
  s_lshr_b32 s62, s3, 1
  s_add_u32 s62, s62, s101
  s_lshl_b32 s62, s62, 3
  s_add_u32 s60, s60, s62
  s_lshl_b32 s60, s60, 11
  s_and_b32 s62, s3, 1
  s_lshl_b32 s63, s30, 1
  s_add_u32 s62, s62, s63
  s_lshl_b32 s62, s62, 5
  s_add_u32 s60, s60, s62
  s_add_u32 s60, s60, 0xc0000
  v_and_b32 v4, 7, v0
  v_lshlrev_b32 v4, 11, v4
  v_lshrrev_b32 v1, 3, v0
  v_lshl_add_u32 v4, v1, 2, v4
  v_add_u32 v4, s60, v4
  v_and_b32 v1, 8, v0
  v_cmp_ne_u32 vcc, 0, v1
  s_waitcnt vmcnt(0)
  v_lshlrev_b32 v96, 16, v64
  v_and_b32 v97, s57, v64
  v_lshlrev_b32 v98, 16, v65
  v_and_b32 v99, s57, v65
  v_lshlrev_b32 v100, 16, v66
  v_and_b32 v101, s57, v66
  v_lshlrev_b32 v102, 16, v67
  v_and_b32 v103, s57, v67
  v_lshlrev_b32 v104, 16, v68
  v_and_b32 v105, s57, v68
  v_lshlrev_b32 v106, 16, v69
  v_and_b32 v107, s57, v69
  v_lshlrev_b32 v108, 16, v70
  v_and_b32 v109, s57, v70
  v_lshlrev_b32 v110, 16, v71
  v_and_b32 v111, s57, v71
  v_lshlrev_b32 v112, 16, v72
  v_and_b32 v113, s57, v72
  v_lshlrev_b32 v114, 16, v73
  v_and_b32 v115, s57, v73
  v_lshlrev_b32 v116, 16, v74
  v_and_b32 v117, s57, v74
  v_lshlrev_b32 v118, 16, v75
  v_and_b32 v119, s57, v75
  v_lshlrev_b32 v120, 16, v76
  v_and_b32 v121, s57, v76
  v_lshlrev_b32 v122, 16, v77
  v_and_b32 v123, s57, v77
  v_lshlrev_b32 v124, 16, v78
  v_and_b32 v125, s57, v78
  v_lshlrev_b32 v126, 16, v79
  v_and_b32 v127, s57, v79
  v_lshlrev_b32 v128, 16, v80
  v_and_b32 v129, s57, v80
  v_lshlrev_b32 v130, 16, v81
  v_and_b32 v131, s57, v81
  v_lshlrev_b32 v132, 16, v82
  v_and_b32 v133, s57, v82
  v_lshlrev_b32 v134, 16, v83
  v_and_b32 v135, s57, v83
  v_lshlrev_b32 v136, 16, v84
  v_and_b32 v137, s57, v84
  v_lshlrev_b32 v138, 16, v85
  v_and_b32 v139, s57, v85
  v_lshlrev_b32 v140, 16, v86
  v_and_b32 v141, s57, v86
  v_lshlrev_b32 v142, 16, v87
  v_and_b32 v143, s57, v87
  v_lshlrev_b32 v144, 16, v88
  v_and_b32 v145, s57, v88
  v_lshlrev_b32 v146, 16, v89
  v_and_b32 v147, s57, v89
  v_lshlrev_b32 v148, 16, v90
  v_and_b32 v149, s57, v90
  v_lshlrev_b32 v150, 16, v91
  v_and_b32 v151, s57, v91
  v_lshlrev_b32 v152, 16, v92
  v_and_b32 v153, s57, v92
  v_lshlrev_b32 v154, 16, v93
  v_and_b32 v155, s57, v93
  v_lshlrev_b32 v156, 16, v94
  v_and_b32 v157, s57, v94
  v_lshlrev_b32 v158, 16, v95
  v_and_b32 v159, s57, v95
  s_barrier
  ds_read_b32 v5, v7 offset:24
  ds_read_b32 v6, v7 offset:12
  ds_read_b128 v[40:43], v3 offset:768
  ds_read_b128 v[44:47], v3 offset:784
  s_waitcnt lgkmcnt(1)
  v_pk_mul_f32 v[16:17], v[96:97], v[40:41] op_sel:[0,0] op_sel_hi:[1,0]
  v_pk_mul_f32 v[18:19], v[98:99], v[40:41] op_sel:[0,0] op_sel_hi:[1,0]
  v_pk_mul_f32 v[20:21], v[100:101], v[40:41] op_sel:[0,0] op_sel_hi:[1,0]
  v_pk_mul_f32 v[22:23], v[102:103], v[40:41] op_sel:[0,0] op_sel_hi:[1,0]
  v_pk_fma_f32 v[16:17], v[104:105], v[40:41], v[16:17] op_sel:[0,1,0] op_sel_hi:[1,1,1]
  v_pk_fma_f32 v[18:19], v[106:107], v[40:41], v[18:19] op_sel:[0,1,0] op_sel_hi:[1,1,1]
  v_pk_fma_f32 v[20:21], v[108:109], v[40:41], v[20:21] op_sel:[0,1,0] op_sel_hi:[1,1,1]
  v_pk_fma_f32 v[22:23], v[110:111], v[40:41], v[22:23] op_sel:[0,1,0] op_sel_hi:[1,1,1]
  v_pk_fma_f32 v[16:17], v[112:113], v[42:43], v[16:17] op_sel:[0,0,0] op_sel_hi:[1,0,1]
  v_pk_fma_f32 v[18:19], v[114:115], v[42:43], v[18:19] op_sel:[0,0,0] op_sel_hi:[1,0,1]
  v_pk_fma_f32 v[20:21], v[116:117], v[42:43], v[20:21] op_sel:[0,0,0] op_sel_hi:[1,0,1]
  v_pk_fma_f32 v[22:23], v[118:119], v[42:43], v[22:23] op_sel:[0,0,0] op_sel_hi:[1,0,1]
  v_pk_fma_f32 v[16:17], v[120:121], v[42:43], v[16:17] op_sel:[0,1,0] op_sel_hi:[1,1,1]
  v_pk_fma_f32 v[18:19], v[122:123], v[42:43], v[18:19] op_sel:[0,1,0] op_sel_hi:[1,1,1]
  v_pk_fma_f32 v[20:21], v[124:125], v[42:43], v[20:21] op_sel:[0,1,0] op_sel_hi:[1,1,1]
  v_pk_fma_f32 v[22:23], v[126:127], v[42:43], v[22:23] op_sel:[0,1,0] op_sel_hi:[1,1,1]
  s_waitcnt lgkmcnt(0)
  v_pk_fma_f32 v[16:17], v[128:129], v[44:45], v[16:17] op_sel:[0,0,0] op_sel_hi:[1,0,1]
  v_pk_fma_f32 v[18:19], v[130:131], v[44:45], v[18:19] op_sel:[0,0,0] op_sel_hi:[1,0,1]
  v_pk_fma_f32 v[20:21], v[132:133], v[44:45], v[20:21] op_sel:[0,0,0] op_sel_hi:[1,0,1]
  v_pk_fma_f32 v[22:23], v[134:135], v[44:45], v[22:23] op_sel:[0,0,0] op_sel_hi:[1,0,1]
  v_pk_fma_f32 v[16:17], v[136:137], v[44:45], v[16:17] op_sel:[0,1,0] op_sel_hi:[1,1,1]
  v_pk_fma_f32 v[18:19], v[138:139], v[44:45], v[18:19] op_sel:[0,1,0] op_sel_hi:[1,1,1]
  v_pk_fma_f32 v[20:21], v[140:141], v[44:45], v[20:21] op_sel:[0,1,0] op_sel_hi:[1,1,1]
  v_pk_fma_f32 v[22:23], v[142:143], v[44:45], v[22:23] op_sel:[0,1,0] op_sel_hi:[1,1,1]
  v_pk_fma_f32 v[16:17], v[144:145], v[46:47], v[16:17] op_sel:[0,0,0] op_sel_hi:[1,0,1]
  v_pk_fma_f32 v[18:19], v[146:147], v[46:47], v[18:19] op_sel:[0,0,0] op_sel_hi:[1,0,1]
  v_pk_fma_f32 v[20:21], v[148:149], v[46:47], v[20:21] op_sel:[0,0,0] op_sel_hi:[1,0,1]
  v_pk_fma_f32 v[22:23], v[150:151], v[46:47], v[22:23] op_sel:[0,0,0] op_sel_hi:[1,0,1]
  v_pk_fma_f32 v[16:17], v[152:153], v[46:47], v[16:17] op_sel:[0,1,0] op_sel_hi:[1,1,1]
  v_pk_fma_f32 v[18:19], v[154:155], v[46:47], v[18:19] op_sel:[0,1,0] op_sel_hi:[1,1,1]
  v_pk_fma_f32 v[20:21], v[156:157], v[46:47], v[20:21] op_sel:[0,1,0] op_sel_hi:[1,1,1]
  v_pk_fma_f32 v[22:23], v[158:159], v[46:47], v[22:23] op_sel:[0,1,0] op_sel_hi:[1,1,1]
L_opred:
  v_readfirstlane_b32 s92, v5
  v_readfirstlane_b32 s93, v6
  v_permlane32_swap_b32 v16, v20
  v_permlane32_swap_b32 v17, v21
  v_permlane32_swap_b32 v18, v22
  v_permlane32_swap_b32 v19, v23
  v_add_f32 v16, v16, v20
  v_add_f32 v17, v17, v21
  v_add_f32 v18, v18, v22
  v_add_f32 v19, v19, v23
  s_nop 0
  v_permlane16_swap_b32 v16, v18
  v_permlane16_swap_b32 v17, v19
  v_add_f32 v16, v16, v18
  v_add_f32 v17, v17, v19
  s_nop 0
  v_add_f32_dpp v16, v16, v16 row_ror:8 row_mask:0xf bank_mask:0xf
  v_add_f32_dpp v17, v17, v17 row_ror:8 row_mask:0xf bank_mask:0xf
  v_cndmask_b32 v16, v16, v17, vcc
  v_mov_b32 v17, 0xff
  v_bfi_b32 v16, v17, s93, v16
  s_cmp_eq_u32 s92, 1
  s_cbranch_scc1 L_o3fast
  global_store_dword v4, v16, s[28:29] sc1
  s_branch L_o3done
L_o3fast:
  global_store_dword v4, v16, s[28:29]
L_o3done:
  s_branch L_fin
L_half:
  s_cmp_eq_u32 s100, 4
  s_cbranch_scc1 L_b2only
  v_lshrrev_b32 v3, 3, v0
  v_lshlrev_b32 v3, 4, v3
  s_sub_u32 s63, s3, 4
  s_lshl_b32 s62, s63, 7
  v_add_u32 v3, s62, v3
  s_cmp_ge_u32 s63, 2
  s_cbranch_scc1 L_hx
  s_lshr_b32 s60, s31, 2
  s_mul_i32 s60, s60, 80
  s_add_u32 s62, s101, 2
  s_lshl_b32 s62, s62, 3
  s_add_u32 s60, s60, s62
  s_lshl_b32 s60, s60, 11
  s_add_u32 s60, s60, 0xc0000
  s_branch L_hy
L_hx:
  s_lshr_b32 s60, s31, 1
  s_lshl_b32 s60, s60, 14
  s_add_u32 s60, s60, 0x110000
L_hy:
  s_and_b32 s62, s63, 1
  s_lshl_b32 s63, s30, 1
  s_add_u32 s62, s62, s63
  s_lshl_b32 s62, s62, 5
  s_add_u32 s60, s60, s62
  v_and_b32 v4, 7, v0
  v_lshlrev_b32 v4, 11, v4
  v_lshrrev_b32 v1, 3, v0
  v_lshl_add_u32 v4, v1, 2, v4
  v_add_u32 v4, s60, v4
  v_and_b32 v1, 8, v0
  v_cmp_ne_u32 vcc, 0, v1
  s_waitcnt vmcnt(0)
  v_lshlrev_b32 v96, 16, v64
  v_and_b32 v97, s57, v64
  v_lshlrev_b32 v98, 16, v65
  v_and_b32 v99, s57, v65
  v_lshlrev_b32 v100, 16, v66
  v_and_b32 v101, s57, v66
  v_lshlrev_b32 v102, 16, v67
  v_and_b32 v103, s57, v67
  v_lshlrev_b32 v104, 16, v68
  v_and_b32 v105, s57, v68
  v_lshlrev_b32 v106, 16, v69
  v_and_b32 v107, s57, v69
  v_lshlrev_b32 v108, 16, v70
  v_and_b32 v109, s57, v70
  v_lshlrev_b32 v110, 16, v71
  v_and_b32 v111, s57, v71
  v_lshlrev_b32 v112, 16, v72
  v_and_b32 v113, s57, v72
  v_lshlrev_b32 v114, 16, v73
  v_and_b32 v115, s57, v73
  v_lshlrev_b32 v116, 16, v74
  v_and_b32 v117, s57, v74
  v_lshlrev_b32 v118, 16, v75
  v_and_b32 v119, s57, v75
  v_lshlrev_b32 v120, 16, v76
  v_and_b32 v121, s57, v76
  v_lshlrev_b32 v122, 16, v77
  v_and_b32 v123, s57, v77
  v_lshlrev_b32 v124, 16, v78
  v_and_b32 v125, s57, v78
  v_lshlrev_b32 v126, 16, v79
  v_and_b32 v127, s57, v79
  s_barrier
  ds_read_b32 v5, v7 offset:24
  ds_read_b32 v6, v7 offset:12
  ds_read_b128 v[40:43], v3 offset:768
  s_waitcnt lgkmcnt(0)
  v_pk_mul_f32 v[16:17], v[96:97], v[40:41] op_sel:[0,0] op_sel_hi:[1,0]
  v_pk_mul_f32 v[18:19], v[98:99], v[40:41] op_sel:[0,0] op_sel_hi:[1,0]
  v_pk_mul_f32 v[20:21], v[100:101], v[40:41] op_sel:[0,0] op_sel_hi:[1,0]
  v_pk_mul_f32 v[22:23], v[102:103], v[40:41] op_sel:[0,0] op_sel_hi:[1,0]
  v_pk_fma_f32 v[16:17], v[104:105], v[40:41], v[16:17] op_sel:[0,1,0] op_sel_hi:[1,1,1]
  v_pk_fma_f32 v[18:19], v[106:107], v[40:41], v[18:19] op_sel:[0,1,0] op_sel_hi:[1,1,1]
  v_pk_fma_f32 v[20:21], v[108:109], v[40:41], v[20:21] op_sel:[0,1,0] op_sel_hi:[1,1,1]
  v_pk_fma_f32 v[22:23], v[110:111], v[40:41], v[22:23] op_sel:[0,1,0] op_sel_hi:[1,1,1]
  v_pk_fma_f32 v[16:17], v[112:113], v[42:43], v[16:17] op_sel:[0,0,0] op_sel_hi:[1,0,1]
  v_pk_fma_f32 v[18:19], v[114:115], v[42:43], v[18:19] op_sel:[0,0,0] op_sel_hi:[1,0,1]
  v_pk_fma_f32 v[20:21], v[116:117], v[42:43], v[20:21] op_sel:[0,0,0] op_sel_hi:[1,0,1]
  v_pk_fma_f32 v[22:23], v[118:119], v[42:43], v[22:23] op_sel:[0,0,0] op_sel_hi:[1,0,1]
  v_pk_fma_f32 v[16:17], v[120:121], v[42:43], v[16:17] op_sel:[0,1,0] op_sel_hi:[1,1,1]
  v_pk_fma_f32 v[18:19], v[122:123], v[42:43], v[18:19] op_sel:[0,1,0] op_sel_hi:[1,1,1]
  v_pk_fma_f32 v[20:21], v[124:125], v[42:43], v[20:21] op_sel:[0,1,0] op_sel_hi:[1,1,1]
  v_pk_fma_f32 v[22:23], v[126:127], v[42:43], v[22:23] op_sel:[0,1,0] op_sel_hi:[1,1,1]
  s_branch L_opred
L_b2only:
  s_barrier
  s_branch L_fin
L_helper:
  v_mov_b32 v8, 0
  v_mov_b32 v9, 0
  v_mov_b32 v10, 0
  v_mov_b32 v11, 0
  ds_write_b128 v7, v[8:11] offset:0
  v_mov_b32 v8, 0xffff0000
  ds_write_b64 v7, v[8:9] offset:16
  ds_write_b32 v7, v9 offset:28
  ds_write_b32 v7, v9 offset:32
  v_lshlrev_b32 v1, 2, v0
  v_mov_b32 v3, -1
  ds_write_b32 v1, v3 offset:54528
  ds_write_b32 v1, v3 offset:54784
  v_mov_b32 v8, -1
  v_mov_b32 v9, -1
  v_mov_b32 v10, -1
  v_mov_b32 v11, -1
  s_lshr_b32 s60, s31, 2
  s_mul_i32 s60, s60, 80
  s_lshl_b32 s62, s101, 3
  s_add_u32 s60, s60, s62
  s_lshl_b32 s60, s60, 11
  s_lshl_b32 s62, s30, 6
  s_add_u32 s60, s60, s62
  s_add_u32 s60, s60, 0xc0000
  v_and_b32 v3, 7, v0
  v_lshlrev_b32 v3, 11, v3
  v_lshrrev_b32 v24, 3, v0
  v_lshl_add_u32 v3, v24, 2, v3
  s_lshr_b32 s63, s31, 1
  s_lshl_b32 s63, s63, 14
  s_add_u32 s63, s63, s62
  s_add_u32 s63, s63, 0x110000
  v_add_u32 v24, s63, v3
  v_add_u32 v3, s60, v3
  s_lshl_b32 s64, s56, 10
  v_add_u32 v1, s64, v2
  s_lshl_b32 s65, s56, 11
  s_add_u32 s65, s65, 0x40000
  v_add_u32 v5, s65, v2
  v_mov_b32 v4, s65
  s_lshl_b32 s66, s30, 8
  s_add_u32 s66, s66, 0x130000
  v_mov_b32 v6, s66
  v_mov_b32 v30, 0x138000
  s_waitcnt lgkmcnt(0)
  global_load_dword v31, v30, s[28:29]
  s_lshl_b32 s64, s30, 20
  s_lshl_b32 s65, s96, 15
  s_add_u32 s65, s65, s64
  s_add_u32 s65, s65, 0xC0000
  v_mov_b32 v12, s65
  s_mul_i32 s60, s96, 131072
  s_add_u32 s64, s64, s60
  v_mov_b32 v13, s64
  s_lshl_b32 s60, s30, 7
  s_mul_i32 s60, s60, 1280
  v_mov_b32 v14, s60
  s_cmp_lt_u32 s31, 4
  s_cselect_b32 s48, s12, s22
  s_cselect_b32 s49, s13, s23
  s_mov_b64 exec, 1
  global_load_dword v20, v12, s[6:7]
  global_load_dword v19, v13, s[16:17]
  global_load_dword v16, v12, s[8:9]
  global_load_dword v17, v13, s[18:19]
  global_load_dword v18, v14, s[48:49]
  global_load_dword v21, v7, s[24:25]
  s_mov_b64 exec, -1
  s_barrier
  s_lshl_b32 s60, s30, 8
  s_add_u32 s60, s60, 0x134000
  s_lshl_b32 s62, s31, 2
  s_add_u32 s62, s62, s60
  v_mov_b32 v1, s62
  v_and_b32 v3, 7, v0
  v_lshlrev_b32 v3, 2, v3
  v_add_u32 v3, s60, v3
  s_waitcnt vmcnt(6)
  v_add_u32 v31, 1, v31
  s_nop 0
  v_readfirstlane_b32 s55, v31
  s_nop 0
  s_and_b32 s35, s55, 0xff
  s_or_b32 s59, s35, 0x100
  v_mov_b32 v26, s59
  ds_write_b32 v7, v26 offset:12
  v_not_b32 v40, s55
  v_not_b32 v41, s55
  v_not_b32 v42, s55
  v_not_b32 v43, s55
  global_store_dwordx4 v5, v[40:43], s[28:29] sc1
  s_mov_b64 exec, 0xff
  global_store_dwordx4 v5, v[40:43], s[28:29] offset:1024 sc1
  s_mov_b64 exec, -1
  s_lshl_b32 s60, s100, 2
  s_cmp_lt_u32 s30, s60
  s_cbranch_scc0 L_noww
  s_lshr_b32 s60, s31, 2
  s_mul_i32 s60, s60, 80
  s_lshl_b32 s62, s101, 3
  s_add_u32 s60, s60, s62
  s_add_u32 s60, s60, s30
  s_min_u32 s60, s60, 159
  s_lshl_b32 s60, s60, 11
  s_add_u32 s60, s60, 0xc0000
  v_add_u32 v27, s60, v2
  global_store_dwordx4 v27, v[40:43], s[28:29] sc1
  global_store_dwordx4 v27, v[40:43], s[28:29] offset:1024 sc1
  s_cmp_lt_u32 s30, 16
  s_cbranch_scc1 L_noww
  s_lshr_b32 s60, s31, 1
  s_lshl_b32 s60, s60, 3
  s_add_u32 s60, s60, s30
  s_sub_i32 s60, s60, 16
  s_max_i32 s60, s60, 0
  s_min_u32 s60, s60, 31
  s_lshl_b32 s60, s60, 11
  s_add_u32 s60, s60, 0x110000
  v_add_u32 v28, s60, v2
  global_store_dwordx4 v28, v[40:43], s[28:29] sc1
  global_store_dwordx4 v28, v[40:43], s[28:29] offset:1024 sc1
L_noww:
  s_cmp_lg_u32 s31, 0
  s_cbranch_scc1 L_nocnt
  global_store_dword v6, v7, s[28:29] sc1
L_nocnt:
  s_waitcnt vmcnt(0)
  s_getreg_b32 s54, hwreg(HW_REG_XCC_ID)
  s_and_b32 s54, s54, 15
  s_and_b32 s53, s55, 0x0fffffff
  s_lshl_b32 s60, s55, 4
  s_or_b32 s60, s60, s54
  v_mov_b32 v31, s60
  s_mov_b64 exec, 1
  global_store_dword v1, v31, s[28:29] sc1
  s_mov_b64 exec, -1
L_hq:
  ds_read_b32 v1, v7 offset:0
  s_waitcnt lgkmcnt(0)
  v_readfirstlane_b32 s60, v1
  s_nop 0
  s_cmp_eq_u32 s60, 8
  s_cbranch_scc1 L_hq_done
  s_sleep 1
  s_sub_u32 s61, s61, 1
  s_cbranch_scc0 L_hq
L_hq_done:
  v_mov_b32 v50, v3
  s_lshl_b32 s60, s30, 13
  v_add_u32 v1, s60, v2
  v_add_u32 v3, 0x1000, v1
  v_lshlrev_b32 v4, 10, v0
  v_add_u32 v4, s60, v4
  v_add_u32 v4, 0x3fc, v4
  s_mov_b64 exec, 0xff
L_g1p:
  global_load_dword v12, v4, s[28:29] sc1
  s_waitcnt vmcnt(0)
  v_xor_b32 v12, s59, v12
  v_and_b32 v12, 0xff, v12
  v_cmp_ne_u32 vcc, 0, v12
  s_nop 4
  s_cbranch_vccz L_g1p_done
  s_sleep 2
  s_sub_u32 s61, s61, 1
  s_cbranch_scc0 L_g1p
L_g1p_done:
  s_mov_b64 exec, -1
L_g1:
  global_load_dwordx4 v[12:15], v1, s[28:29] offset:0 sc1
  global_load_dwordx4 v[16:19], v1, s[28:29] offset:1024 sc1
  global_load_dwordx4 v[20:23], v1, s[28:29] offset:2048 sc1
  global_load_dwordx4 v[24:27], v1, s[28:29] offset:3072 sc1
  global_load_dwordx4 v[28:31], v3, s[28:29] offset:0 sc1
  global_load_dwordx4 v[32:35], v3, s[28:29] offset:1024 sc1
  global_load_dwordx4 v[36:39], v3, s[28:29] offset:2048 sc1
  global_load_dwordx4 v[40:43], v3, s[28:29] offset:3072 sc1
  s_waitcnt vmcnt(0)
  v_xor_b32 v12, s35, v12
  v_xor_b32 v13, s35, v13
  v_or_b32 v44, v12, v13
  v_xor_b32 v14, s35, v14
  v_xor_b32 v15, s35, v15
  v_or3_b32 v44, v14, v15, v44
  v_xor_b32 v16, s35, v16
  v_xor_b32 v17, s35, v17
  v_or3_b32 v44, v16, v17, v44
  v_xor_b32 v18, s35, v18
  v_xor_b32 v19, s35, v19
  v_or3_b32 v44, v18, v19, v44
  v_xor_b32 v20, s35, v20
  v_xor_b32 v21, s35, v21
  v_or3_b32 v44, v20, v21, v44
  v_xor_b32 v22, s35, v22
  v_xor_b32 v23, s35, v23
  v_or3_b32 v44, v22, v23, v44
  v_xor_b32 v24, s35, v24
  v_xor_b32 v25, s35, v25
  v_or3_b32 v44, v24, v25, v44
  v_xor_b32 v26, s35, v26
  v_xor_b32 v27, s35, v27
  v_or3_b32 v44, v26, v27, v44
  v_xor_b32 v28, s35, v28
  v_xor_b32 v29, s35, v29
  v_or3_b32 v44, v28, v29, v44
  v_xor_b32 v30, s35, v30
  v_xor_b32 v31, s35, v31
  v_or3_b32 v44, v30, v31, v44
  v_xor_b32 v32, s35, v32
  v_xor_b32 v33, s35, v33
  v_or3_b32 v44, v32, v33, v44
  v_xor_b32 v34, s35, v34
  v_xor_b32 v35, s35, v35
  v_or3_b32 v44, v34, v35, v44
  v_xor_b32 v36, s35, v36
  v_xor_b32 v37, s35, v37
  v_or3_b32 v44, v36, v37, v44
  v_xor_b32 v38, s35, v38
  v_xor_b32 v39, s35, v39
  v_or3_b32 v44, v38, v39, v44
  v_xor_b32 v40, s35, v40
  v_xor_b32 v41, s35, v41
  v_or3_b32 v44, v40, v41, v44
  v_xor_b32 v42, s35, v42
  v_xor_b32 v43, s35, v43
  v_or3_b32 v44, v42, v43, v44
  v_and_b32 v44, 0xff, v44
  v_cmp_ne_u32 vcc, 0, v44
  s_nop 4
  s_cbranch_vccz L_g1_done
  s_sleep 2
  s_sub_u32 s61, s61, 1
  s_cbranch_scc0 L_g1
L_g1_done:
  v_add_f32 v12, v12, v16
  v_add_f32 v13, v13, v17
  v_add_f32 v14, v14, v18
  v_add_f32 v15, v15, v19
  v_add_f32 v12, v12, v20
  v_add_f32 v13, v13, v21
  v_add_f32 v14, v14, v22
  v_add_f32 v15, v15, v23
  v_add_f32 v12, v12, v24
  v_add_f32 v13, v13, v25
  v_add_f32 v14, v14, v26
  v_add_f32 v15, v15, v27
  v_add_f32 v12, v12, v28
  v_add_f32 v13, v13, v29
  v_add_f32 v14, v14, v30
  v_add_f32 v15, v15, v31
  v_add_f32 v12, v12, v32
  v_add_f32 v13, v13, v33
  v_add_f32 v14, v14, v34
  v_add_f32 v15, v15, v35
  v_add_f32 v12, v12, v36
  v_add_f32 v13, v13, v37
  v_add_f32 v14, v14, v38
  v_add_f32 v15, v15, v39
  v_add_f32 v12, v12, v40
  v_add_f32 v13, v13, v41
  v_add_f32 v14, v14, v42
  v_add_f32 v15, v15, v43
  v_cvt_pk_bf16_f32 v12, v12, v13
  v_cvt_pk_bf16_f32 v13, v14, v15
  v_lshlrev_b32 v1, 3, v0
  ds_write_b64 v1, v[12:13] offset:256
  s_waitcnt lgkmcnt(0)
  v_mov_b32 v3, 1
  ds_write_b32 v7, v3 offset:8
L_pf:
  global_load_dword v4, v50, s[28:29] sc1
  s_waitcnt vmcnt(0)
  v_lshrrev_b32 v4, 4, v4
  v_cmp_ne_u32 vcc, s53, v4
  s_nop 4
  s_cbranch_vccz L_pf_done
  s_sleep 4
  s_sub_u32 s61, s61, 1
  s_cbranch_scc0 L_pf
L_pf_done:
  s_cmp_lt_u32 s31, 4
  s_cselect_b32 s48, s12, s22
  s_cselect_b32 s49, s13, s23
  s_mov_b32 s50, 0x500000
  s_mov_b32 s51, 0x00020000
  v_lshrrev_b32 v1, 3, v0
  v_mul_u32_u24 v1, 10240, v1
  v_and_b32 v3, 7, v0
  v_lshl_add_u32 v1, v3, 4, v1
  s_lshl_b32 s60, s30, 7
  s_lshr_b32 s62, s31, 1
  s_and_b32 s62, s62, 1
  s_lshl_b32 s62, s62, 6
  s_add_u32 s60, s60, s62
  s_mul_i32 s60, s60, 1280
  s_and_b32 s62, s31, 1
  s_mul_i32 s62, s62, 640
  s_add_u32 s60, s60, s62
  s_mov_b32 s64, 0
  s_mov_b32 s33, 56
  s_lshl_b32 s66, s30, 8
  s_add_u32 s66, s66, 0x130000
  v_mov_b32 v6, s66
  v_mov_b32 v5, 1
  s_mov_b32 s33, 40
  v_mov_b32 v8, -1
  v_lshlrev_b32 v1, 2, v0
L_cl:
  ds_read_b64 v[12:13], v7 offset:16
  v_mov_b32 v11, v8
  v_cmp_gt_u32 vcc, 48, v11
  v_add_u32 v9, 16, v11
  s_nop 0
  v_cndmask_b32 v9, -1, v9, vcc
  ds_write_b32 v1, v9 offset:54528
  v_cmp_le_u32 s[88:89], s33, v11
  v_cmp_ne_u32 vcc, -1, v11
  s_nop 0
  s_and_b64 s[88:89], s[88:89], vcc
  s_cbranch_scc1 L_cl_fin
  s_waitcnt lgkmcnt(1)
  v_add_u32 v12, v12, v13
  s_nop 0
  v_readfirstlane_b32 s60, v12
  s_nop 0
  s_add_i32 s60, s60, 32
  s_lshl_b32 s62, s64, 3
  s_cmp_ge_u32 s64, 64
  s_cbranch_scc1 L_cl_cap
  s_cmp_gt_i32 s60, s62
  s_cbranch_scc1 L_cl_go
  s_sleep 1
  s_sub_u32 s61, s61, 1
  s_cbranch_scc0 L_cl
  s_branch L_cl_fin
L_cl_go:
  s_lshl_b64 s[62:63], 1, s64
  s_mov_b64 exec, s[62:63]
  global_atomic_add v8, v6, v5, s[28:29] sc0 sc1
  s_mov_b64 exec, -1
  s_add_u32 s64, s64, 1
  s_branch L_cl
L_cl_cap:
L_cl_fin:
  s_waitcnt vmcnt(0)
  v_cmp_gt_u32 vcc, 48, v8
  v_add_u32 v9, 16, v8
  s_bcnt1_i32_b64 s64, vcc
  v_mbcnt_lo_u32_b32 v10, vcc_lo, 0
  v_mbcnt_hi_u32_b32 v10, vcc_hi, v10
  v_lshlrev_b32 v10, 2, v10
  s_mov_b64 exec, vcc
  s_cbranch_execz L_cl_nov
  ds_write_b32 v10, v9 offset:54528
L_cl_nov:
  s_mov_b64 exec, -1
  s_lshl_b32 s62, s64, 3
  s_add_u32 s62, s62, 1
  v_mov_b32 v8, s62
  ds_write_b32 v7, v8 offset:4
L_cl_done:
  v_lshrrev_b32 v1, 1, v0
  v_lshlrev_b32 v1, 8, v1
  v_and_b32 v3, 1, v0
  v_lshl_add_u32 v1, v3, 4, v1
  v_add_u32 v1, 0x134000, v1
L_pa:
  global_load_dwordx4 v[12:15], v1, s[28:29] sc1
  s_waitcnt vmcnt(0)
  v_lshrrev_b32 v16, 4, v12
  v_lshrrev_b32 v17, 4, v13
  v_lshrrev_b32 v18, 4, v14
  v_lshrrev_b32 v19, 4, v15
  v_xor_b32 v16, s53, v16
  v_xor_b32 v17, s53, v17
  v_xor_b32 v18, s53, v18
  v_xor_b32 v19, s53, v19
  v_or3_b32 v16, v16, v17, v18
  v_or_b32 v16, v16, v19
  v_cmp_ne_u32 vcc, 0, v16
  s_nop 4
  s_cbranch_vccz L_pa_done
  s_sleep 4
  s_sub_u32 s61, s61, 1
  s_cbranch_scc0 L_pa
L_pa_done:
  s_and_b32 s60, s31, 3
  s_cmp_eq_u32 s60, 1
  v_mov_b32 v16, v12
  s_cselect_b64 vcc, -1, 0
  v_cndmask_b32 v16, v16, v13, vcc
  s_cmp_eq_u32 s60, 2
  s_cselect_b64 vcc, -1, 0
  v_cndmask_b32 v16, v16, v14, vcc
  s_cmp_eq_u32 s60, 3
  s_cselect_b64 vcc, -1, 0
  v_cndmask_b32 v16, v16, v15, vcc
  v_and_b32 v16, 15, v16
  v_cmp_ne_u32 vcc, s54, v16
  s_lshr_b32 s60, s31, 2
  s_mov_b32 s62, 0x55555555
  s_lshl_b32 s62, s62, s60
  s_and_b32 s63, vcc_lo, s62
  s_and_b32 s62, vcc_hi, s62
  s_or_b32 s62, s62, s63
  s_cmp_eq_u32 s62, 0
  s_cselect_b32 s52, 1, 0
  v_mov_b32 v16, s52
  ds_write_b32 v7, v16 offset:24
  s_lshl_b32 s60, s56, 11
  s_add_u32 s60, s60, 0x40000
  v_add_u32 v6, s60, v2
  v_lshrrev_b32 v9, 5, v0
  v_lshlrev_b32 v9, 6, v9
  v_add_u32 v9, s60, v9
  v_and_b32 v12, 3, v0
  v_lshl_add_u32 v9, v12, 4, v9
  s_lshr_b32 s60, s31, 2
  s_lshl_b32 s60, s60, 9
  s_lshl_b32 s62, s30, 14
  s_add_u32 s60, s60, s62
  s_add_u32 s60, s60, 0x40000
  v_lshlrev_b32 v1, 3, v0
  v_add_u32 v1, s60, v1
  v_add_u32 v3, 0x1000, v1
  v_add_u32 v4, 0x2000, v1
  v_add_u32 v10, 0x3000, v1
  s_lshr_b32 s60, s31, 2
  s_lshl_b32 s60, s60, 6
  s_add_u32 s60, s60, s62
  s_add_u32 s60, s60, 0x40400
  v_and_b32 v8, 7, v0
  v_lshlrev_b32 v8, 11, v8
  v_add_u32 v8, s60, v8
  v_lshlrev_b32 v5, 3, v0
  v_lshrrev_b32 v11, 5, v0
  v_lshlrev_b32 v11, 3, v11
  s_lshl_b32 s60, s100, 2
  s_cmp_lt_u32 s30, s60
  s_cselect_b32 s51, 1, 0
  s_lshr_b32 s60, s31, 2
  s_mul_i32 s60, s60, 80
  s_lshl_b32 s62, s101, 3
  s_add_u32 s60, s60, s62
  s_add_u32 s60, s60, s30
  s_min_u32 s60, s60, 159
  s_lshl_b32 s63, s60, 4
  s_lshl_b32 s60, s60, 11
  s_add_u32 s60, s60, 0xc0000
  v_add_u32 v84, s60, v2
  v_lshlrev_b32 v86, 3, v0
  v_add_u32 v86, s63, v86
  s_lshr_b32 s60, s31, 1
  s_lshl_b32 s60, s60, 3
  s_add_u32 s60, s60, s30
  s_sub_i32 s60, s60, 16
  s_max_i32 s60, s60, 0
  s_min_u32 s60, s60, 31
  s_lshl_b32 s60, s60, 11
  s_add_u32 s60, s60, 0x110000
  v_add_u32 v85, s60, v2
  s_waitcnt vmcnt(0) lgkmcnt(0)
  s_mov_b32 s36, 1
  s_mov_b32 s37, 0
  v_not_b32 v106, s55
L_hw:
  ds_read_b32 v28, v7 offset:28
  s_cmp_lg_u32 s36, 0
  s_cbranch_scc1 L_hw_c
  s_cmp_lg_u32 s37, 0
  s_cbranch_scc1 L_hw_n
  global_load_dwordx4 v[104:107], v8, s[28:29] sc1
  s_mov_b32 s37, 6
L_hw_n:
  s_sub_u32 s37, s37, 1
  v_cmp_eq_u32 vcc, s55, v106
  s_nop 0
  s_bcnt1_i32_b64 s60, vcc
  s_cmp_lt_u32 s60, 72
  s_cbranch_scc1 L_hw_c
  s_mov_b32 s36, 1
  v_mov_b32 v29, 1
  ds_write_b32 v7, v29 offset:32
L_hw_c:
  s_waitcnt lgkmcnt(0)
  v_readfirstlane_b32 s60, v28
  s_nop 0
  s_cmp_eq_u32 s60, 8
  s_cbranch_scc1 L_hw_done
  s_sleep 1
  s_sub_u32 s61, s61, 1
  s_cbranch_scc0 L_hw
L_hw_done:
L_htail:
  ds_read_b64 v[64:65], v11 offset:64
  ds_read_b64 v[66:67], v11 offset:80
  ds_read_b64 v[68:69], v11 offset:96
  ds_read_b64 v[70:71], v11 offset:112
  ds_read_b64 v[72:73], v11 offset:128
  ds_read_b64 v[74:75], v11 offset:144
  ds_read_b64 v[76:77], v11 offset:160
  ds_read_b64 v[78:79], v11 offset:176
  ds_read_b128 v[12:15], v2 offset:5376
  ds_read_b128 v[16:19], v2 offset:6400
  ds_read_b128 v[20:23], v2 offset:7424
  ds_read_b128 v[24:27], v2 offset:8448
  ds_read_b128 v[28:31], v2 offset:9472
  ds_read_b128 v[32:35], v2 offset:10496
  ds_read_b128 v[36:39], v2 offset:11520
  ds_read_b128 v[40:43], v2 offset:12544
  s_waitcnt lgkmcnt(8)
  v_max3_f32 v80, v64, v66, v68
  v_max3_f32 v80, v80, v70, v72
  v_max3_f32 v80, v80, v74, v76
  v_max_f32 v80, v80, v78
  v_sub_f32 v64, v64, v80
  v_sub_f32 v66, v66, v80
  v_sub_f32 v68, v68, v80
  v_sub_f32 v70, v70, v80
  v_sub_f32 v72, v72, v80
  v_sub_f32 v74, v74, v80
  v_sub_f32 v76, v76, v80
  v_sub_f32 v78, v78, v80
  v_mul_f32 v64, s58, v64
  v_mul_f32 v66, s58, v66
  v_mul_f32 v68, s58, v68
  v_mul_f32 v70, s58, v70
  v_mul_f32 v72, s58, v72
  v_mul_f32 v74, s58, v74
  v_mul_f32 v76, s58, v76
  v_mul_f32 v78, s58, v78
  v_exp_f32 v64, v64
  v_exp_f32 v66, v66
  v_exp_f32 v68, v68
  v_exp_f32 v70, v70
  v_exp_f32 v72, v72
  v_exp_f32 v74, v74
  v_exp_f32 v76, v76
  v_exp_f32 v78, v78
  v_mul_f32 v81, v64, v65
  v_fmac_f32 v81, v66, v67
  v_fmac_f32 v81, v68, v69
  v_fmac_f32 v81, v70, v71
  v_fmac_f32 v81, v72, v73
  v_fmac_f32 v81, v74, v75
  v_fmac_f32 v81, v76, v77
  v_fmac_f32 v81, v78, v79
  s_waitcnt lgkmcnt(0)
  v_pk_mul_f32 v[44:45], v[12:13], v[64:65] op_sel:[0,0] op_sel_hi:[1,0]
  v_pk_mul_f32 v[46:47], v[14:15], v[64:65] op_sel:[0,0] op_sel_hi:[1,0]
  v_pk_fma_f32 v[44:45], v[16:17], v[66:67], v[44:45] op_sel:[0,0,0] op_sel_hi:[1,0,1]
  v_pk_fma_f32 v[46:47], v[18:19], v[66:67], v[46:47] op_sel:[0,0,0] op_sel_hi:[1,0,1]
  v_pk_fma_f32 v[44:45], v[20:21], v[68:69], v[44:45] op_sel:[0,0,0] op_sel_hi:[1,0,1]
  v_pk_fma_f32 v[46:47], v[22:23], v[68:69], v[46:47] op_sel:[0,0,0] op_sel_hi:[1,0,1]
  v_pk_fma_f32 v[44:45], v[24:25], v[70:71], v[44:45] op_sel:[0,0,0] op_sel_hi:[1,0,1]
  v_pk_fma_f32 v[46:47], v[26:27], v[70:71], v[46:47] op_sel:[0,0,0] op_sel_hi:[1,0,1]
  v_pk_fma_f32 v[44:45], v[28:29], v[72:73], v[44:45] op_sel:[0,0,0] op_sel_hi:[1,0,1]
  v_pk_fma_f32 v[46:47], v[30:31], v[72:73], v[46:47] op_sel:[0,0,0] op_sel_hi:[1,0,1]
  v_pk_fma_f32 v[44:45], v[32:33], v[74:75], v[44:45] op_sel:[0,0,0] op_sel_hi:[1,0,1]
  v_pk_fma_f32 v[46:47], v[34:35], v[74:75], v[46:47] op_sel:[0,0,0] op_sel_hi:[1,0,1]
  v_pk_fma_f32 v[44:45], v[36:37], v[76:77], v[44:45] op_sel:[0,0,0] op_sel_hi:[1,0,1]
  v_pk_fma_f32 v[46:47], v[38:39], v[76:77], v[46:47] op_sel:[0,0,0] op_sel_hi:[1,0,1]
  v_pk_fma_f32 v[44:45], v[40:41], v[78:79], v[44:45] op_sel:[0,0,0] op_sel_hi:[1,0,1]
  v_pk_fma_f32 v[46:47], v[42:43], v[78:79], v[46:47] op_sel:[0,0,0] op_sel_hi:[1,0,1]
  v_mov_b32 v12, 0xff
  v_mov_b32 v82, s55
  v_mov_b32 v83, s55
  v_bfi_b32 v44, v12, s59, v44
  v_bfi_b32 v45, v12, s59, v45
  v_bfi_b32 v46, v12, s59, v46
  v_bfi_b32 v47, v12, s59, v47
  s_cbranch_execz L_gt12
  global_store_dwordx4 v6, v[44:47], s[28:29] sc1
L_gt12:
  v_and_b32 v12, 28, v0
  v_cmp_eq_u32 vcc, 0, v12
  s_nop 0
  s_and_saveexec_b64 s[62:63], vcc
  s_cbranch_execz L_gt13
  global_store_dwordx4 v9, v[80:83], s[28:29] offset:1024 sc1
L_gt13:
  s_mov_b64 exec, s[62:63]
L_g2:
  s_cbranch_execz L_gt14
  global_load_dwordx2 v[12:13], v1, s[28:29] offset:0 sc1
  global_load_dwordx2 v[14:15], v1, s[28:29] offset:2048 sc1
  global_load_dwordx2 v[16:17], v3, s[28:29] offset:0 sc1
  global_load_dwordx2 v[18:19], v3, s[28:29] offset:2048 sc1
  global_load_dwordx2 v[20:21], v4, s[28:29] offset:0 sc1
  global_load_dwordx2 v[22:23], v4, s[28:29] offset:2048 sc1
  global_load_dwordx2 v[24:25], v10, s[28:29] offset:0 sc1
  global_load_dwordx2 v[26:27], v10, s[28:29] offset:2048 sc1
  global_load_dwordx4 v[30:33], v8, s[28:29] sc1
  s_waitcnt vmcnt(0)
L_gt14:
  v_xor_b32 v12, s35, v12
  v_xor_b32 v13, s35, v13
  v_or_b32 v28, v12, v13
  v_xor_b32 v14, s35, v14
  v_xor_b32 v15, s35, v15
  v_or3_b32 v28, v14, v15, v28
  v_xor_b32 v16, s35, v16
  v_xor_b32 v17, s35, v17
  v_or3_b32 v28, v16, v17, v28
  v_xor_b32 v18, s35, v18
  v_xor_b32 v19, s35, v19
  v_or3_b32 v28, v18, v19, v28
  v_xor_b32 v20, s35, v20
  v_xor_b32 v21, s35, v21
  v_or3_b32 v28, v20, v21, v28
  v_xor_b32 v22, s35, v22
  v_xor_b32 v23, s35, v23
  v_or3_b32 v28, v22, v23, v28
  v_xor_b32 v24, s35, v24
  v_xor_b32 v25, s35, v25
  v_or3_b32 v28, v24, v25, v28
  v_xor_b32 v26, s35, v26
  v_xor_b32 v27, s35, v27
  v_or3_b32 v28, v26, v27, v28
  v_and_b32 v28, 0xff, v28
  v_xor_b32 v29, s55, v32
  v_or_b32 v28, v28, v29
  v_cmp_ne_u32 vcc, 0, v28
  s_nop 4
  s_cbranch_vccz L_g2_done
  s_cmp_lg_u32 s36, 0
  s_cbranch_scc1 L_g2w
  v_cmp_eq_u32 vcc, s55, v32
  s_nop 0
  s_bcnt1_i32_b64 s60, vcc
  s_cmp_lt_u32 s60, 72
  s_cbranch_scc1 L_g2w
  s_mov_b32 s36, 1
  v_mov_b32 v29, 1
  ds_write_b32 v7, v29 offset:32
L_g2w:
  s_sub_u32 s61, s61, 1
  s_cbranch_scc0 L_g2
L_g2_done:
  s_cmp_lg_u32 s36, 0
  s_cbranch_scc1 L_g2x
  v_mov_b32 v29, 1
  ds_write_b32 v7, v29 offset:32
L_g2x:
  v_mov_b32 v32, v30
  s_nop 1
  v_max_f32_dpp v32, v32, v32 row_ror:4 row_mask:0xf bank_mask:0xf
  s_nop 1
  v_max_f32_dpp v32, v32, v32 row_ror:2 row_mask:0xf bank_mask:0xf
  s_nop 1
  v_max_f32_dpp v32, v32, v32 row_ror:1 row_mask:0xf bank_mask:0xf
  v_sub_f32 v33, v30, v32
  v_mul_f32 v33, s58, v33
  v_exp_f32 v33, v33
  s_nop 0
  v_mul_f32 v34, v33, v31
  s_nop 1
  v_add_f32_dpp v34, v34, v34 row_ror:4 row_mask:0xf bank_mask:0xf
  s_nop 1
  v_add_f32_dpp v34, v34, v34 row_ror:2 row_mask:0xf bank_mask:0xf
  s_nop 1
  v_add_f32_dpp v34, v34, v34 row_ror:1 row_mask:0xf bank_mask:0xf
  v_rcp_f32 v34, v34
  s_nop 0
  v_mul_f32 v33, v33, v34
  s_nop 0
  v_readlane_b32 s40, v33, 0
  v_readlane_b32 s41, v33, 1
  v_readlane_b32 s42, v33, 2
  v_readlane_b32 s43, v33, 3
  v_readlane_b32 s44, v33, 4
  v_readlane_b32 s45, v33, 5
  v_readlane_b32 s46, v33, 6
  v_readlane_b32 s47, v33, 7
  v_mul_f32 v12, s40, v12
  v_mul_f32 v13, s40, v13
  v_fmac_f32 v12, s41, v14
  v_fmac_f32 v13, s41, v15
  v_fmac_f32 v12, s42, v16
  v_fmac_f32 v13, s42, v17
  v_fmac_f32 v12, s43, v18
  v_fmac_f32 v13, s43, v19
  v_fmac_f32 v12, s44, v20
  v_fmac_f32 v13, s44, v21
  v_fmac_f32 v12, s45, v22
  v_fmac_f32 v13, s45, v23
  v_fmac_f32 v12, s46, v24
  v_fmac_f32 v13, s46, v25
  v_fmac_f32 v12, s47, v26
  v_fmac_f32 v13, s47, v27
  ds_write_b64 v5, v[12:13] offset:768
  s_waitcnt lgkmcnt(0)
  s_cbranch_execz L_gt15
  s_barrier
L_gt15:
  s_cmp_eq_u32 s51, 0
  s_cbranch_scc1 L_fin
  v_mov_b32 v20, 0
  v_mov_b32 v21, 0
  v_mov_b32 v22, 0
  v_mov_b32 v23, 0
  v_mov_b32 v24, 0
  v_mov_b32 v25, 0
  v_mov_b32 v26, 0
  v_mov_b32 v27, 0
L_g3:
  global_load_dwordx4 v[12:15], v84, s[28:29] sc1
  global_load_dwordx4 v[16:19], v84, s[28:29] offset:1024 sc1
  s_cmp_lt_u32 s30, 16
  s_cbranch_scc1 L_g3n
  global_load_dwordx4 v[20:23], v85, s[28:29] sc1
  global_load_dwordx4 v[24:27], v85, s[28:29] offset:1024 sc1
L_g3n:
  s_waitcnt vmcnt(0)
  v_xor_b32 v12, s35, v12
  v_xor_b32 v13, s35, v13
  v_or_b32 v28, v12, v13
  v_xor_b32 v14, s35, v14
  v_xor_b32 v15, s35, v15
  v_or3_b32 v28, v14, v15, v28
  v_xor_b32 v16, s35, v16
  v_xor_b32 v17, s35, v17
  v_or3_b32 v28, v16, v17, v28
  v_xor_b32 v18, s35, v18
  v_xor_b32 v19, s35, v19
  v_or3_b32 v28, v18, v19, v28
  s_cmp_lt_u32 s30, 16
  s_cbranch_scc1 L_g3m
  v_xor_b32 v20, s35, v20
  v_xor_b32 v21, s35, v21
  v_or3_b32 v28, v20, v21, v28
  v_xor_b32 v22, s35, v22
  v_xor_b32 v23, s35, v23
  v_or3_b32 v28, v22, v23, v28
  v_xor_b32 v24, s35, v24
  v_xor_b32 v25, s35, v25
  v_or3_b32 v28, v24, v25, v28
  v_xor_b32 v26, s35, v26
  v_xor_b32 v27, s35, v27
  v_or3_b32 v28, v26, v27, v28
L_g3m:
  v_and_b32 v28, 0xff, v28
  v_cmp_ne_u32 vcc, 0, v28
  s_nop 4
  s_cbranch_vccz L_g3_done
  s_sub_u32 s61, s61, 1
  s_cbranch_scc0 L_g3
L_g3_done:
  v_add_f32 v12, v12, v16
  v_add_f32 v20, v20, v24
  v_add_f32 v13, v13, v17
  v_add_f32 v21, v21, v25
  v_add_f32 v14, v14, v18
  v_add_f32 v22, v22, v26
  v_add_f32 v15, v15, v19
  v_add_f32 v23, v23, v27
  v_add_f32 v12, v12, v20
  v_add_f32 v13, v13, v21
  v_add_f32 v14, v14, v22
  v_add_f32 v15, v15, v23
  v_add_f32_dpp v12, v12, v12 row_ror:2 row_mask:0xf bank_mask:0xf
  v_add_f32_dpp v13, v13, v13 row_ror:2 row_mask:0xf bank_mask:0xf
  v_add_f32_dpp v14, v14, v14 row_ror:2 row_mask:0xf bank_mask:0xf
  v_add_f32_dpp v15, v15, v15 row_ror:2 row_mask:0xf bank_mask:0xf
  v_add_f32_dpp v12, v12, v12 row_ror:4 row_mask:0xf bank_mask:0xf
  v_add_f32_dpp v13, v13, v13 row_ror:4 row_mask:0xf bank_mask:0xf
  v_add_f32_dpp v14, v14, v14 row_ror:4 row_mask:0xf bank_mask:0xf
  v_add_f32_dpp v15, v15, v15 row_ror:4 row_mask:0xf bank_mask:0xf
  v_add_f32_dpp v12, v12, v12 row_ror:8 row_mask:0xf bank_mask:0xf
  v_add_f32_dpp v13, v13, v13 row_ror:8 row_mask:0xf bank_mask:0xf
  v_add_f32_dpp v14, v14, v14 row_ror:8 row_mask:0xf bank_mask:0xf
  v_add_f32_dpp v15, v15, v15 row_ror:8 row_mask:0xf bank_mask:0xf
  v_mov_b32 v16, v12
  v_mov_b32 v17, v13
  v_mov_b32 v18, v14
  v_mov_b32 v19, v15
  v_permlane32_swap_b32 v12, v16
  v_permlane32_swap_b32 v13, v17
  v_permlane32_swap_b32 v14, v18
  v_permlane32_swap_b32 v15, v19
  v_add_f32 v12, v12, v16
  v_add_f32 v13, v13, v17
  v_add_f32 v14, v14, v18
  v_add_f32 v15, v15, v19
  v_mov_b32 v16, v12
  v_mov_b32 v17, v13
  v_mov_b32 v18, v14
  v_mov_b32 v19, v15
  v_permlane16_swap_b32 v12, v16
  v_permlane16_swap_b32 v13, v17
  v_permlane16_swap_b32 v14, v18
  v_permlane16_swap_b32 v15, v19
  v_add_f32 v12, v12, v16
  v_add_f32 v13, v13, v17
  v_add_f32 v14, v14, v18
  v_add_f32 v15, v15, v19
  v_cvt_pk_bf16_f32 v12, v12, v13
  v_cvt_pk_bf16_f32 v13, v14, v15
  s_and_b64 exec, s[90:91], 3
  s_cbranch_execz L_gt16
  global_store_dwordx2 v86, v[12:13], s[24:25]
L_gt16:
  s_and_b64 exec, s[90:91], -1
  s_cmp_lg_u32 s2, 0
  s_cbranch_scc1 L_noepo
  v_mov_b32 v30, 0x138000
  v_mov_b32 v31, s55
  s_mov_b64 exec, 1
  global_store_dword v30, v31, s[28:29]
  s_mov_b64 exec, -1
L_noepo:
L_fin:
L_end:
  s_endpgm
.fill 2048, 4, 0xBF800000
.section .rodata,"a"
.p2align 6
.amdhsa_kernel concat_heads__sliding_block_cached__gqa_block_cached__decode_kernel
  .amdhsa_next_free_vgpr 168
  .amdhsa_next_free_sgpr 102
  .amdhsa_accum_offset 168
  .amdhsa_group_segment_fixed_size 0
  .amdhsa_kernarg_size 104
  .amdhsa_user_sgpr_count 2
  .amdhsa_user_sgpr_kernarg_segment_ptr 1
  .amdhsa_system_sgpr_workgroup_id_x 1
.end_amdhsa_kernel
```
